```python
import torch

def _softmax(x, axis=-1):
    return torch.softmax(x, dim=axis)
def _gelu(x):
    return torch.nn.functional.gelu(x, approximate="tanh")
def _silu(x):
    return torch.nn.functional.silu(x)
def _sigmoid(x):
    return torch.sigmoid(x)
def _layernorm(x, axis=-1, eps=1e-5):
    m = x.mean(dim=axis, keepdim=True)
    v = x.var(dim=axis, keepdim=True, unbiased=False)
    return (x - m) / torch.sqrt(v + eps)
def _scatter_add(tgt, idx, src, axis=0):
    return tgt.clone().index_add_(axis, idx, src)
def _segment_sum(src, seg, n):
    out = torch.zeros((n,) + src.shape[1:], dtype=src.dtype)
    return out.index_add_(0, seg, src)
def _pad(x, pw):
    flat = tuple(v for pair in reversed(pw) for v in pair)
    return torch.nn.functional.pad(x, flat)

kernel_name = 'recurrent_scan__mha_block__glu_gated_swiglu__prompt'

def setup_inputs():

    _w = (lambda a: (lambda t: t.to(torch.bfloat16) if t.is_floating_point() else t)(torch.as_tensor(a)))
    def _A_setup():
        B, S, D, H = 1, 2048, 512, 32
        return {
            "x": _w((lambda *s: torch.randn(*s, dtype=torch.bfloat16) * 0.05)(B, S, D)),
            "wqkv": _w((lambda *s: torch.randn(*s, dtype=torch.bfloat16) * 0.2)(D, 3 * D)),
            "wo": _w((lambda *s: torch.randn(*s, dtype=torch.bfloat16) * 0.2)(D, D)),
        }
    _A_in = _A_setup()

    def _B_setup():
        B, S, D, F = 1, 2048, 512, 1376
        return {
            "x": _w((lambda *s: torch.randn(*s, dtype=torch.bfloat16) * 0.05)(B, S, D)),
            "w1": _w((lambda *s: torch.randn(*s, dtype=torch.bfloat16) * 0.1)(D, F) * (2.0 / D) ** 0.5),
            "w3": _w((lambda *s: torch.randn(*s, dtype=torch.bfloat16) * 0.1)(D, F) * (2.0 / D) ** 0.5),
            "w2": _w((lambda *s: torch.randn(*s, dtype=torch.bfloat16) * 0.1)(F, D) * (2.0 / F) ** 0.5),
        }
    _B_in = _B_setup()

    return {
        "A_x": _A_in["x"],
        "A_wqkv": _A_in["wqkv"],
        "A_wo": _A_in["wo"],
        "B_x": _B_in["x"],
        "B_w1": _B_in["w1"],
        "B_w3": _B_in["w3"],
        "B_w2": _B_in["w2"],
    }

def reference(A_x, A_wqkv, A_wo, B_x, B_w1, B_w3, B_w2):
    def _A_ref(x, wqkv, wo):
        B, S, D = x.shape
        H = 32
        Dh = D // H
        qkv = (lambda x, *d: x.permute(*d))((x @ wqkv).reshape(B, S, 3, H, Dh), 2, 0, 3, 1, 4)
        q, k, v = qkv[0], qkv[1], qkv[2]
        scores = torch.einsum("bhqd,bhkd->bhqk", q, k) * (Dh ** -0.5)
        p = _softmax(scores, axis=-1)
        o = torch.einsum("bhqk,bhkd->bhqd", p, v)
        return (lambda x, *d: x.permute(*d))(o, 0, 2, 1, 3).reshape(B, S, D) @ wo

    def _B_ref(x, w1, w3, w2):
        gate = torch.einsum("bsd,df->bsf", x, w1)
        up = torch.einsum("bsd,df->bsf", x, w3)
        h = _silu(gate) * up
        out = torch.einsum("bsf,fd->bsd", h, w2)
        return out

    x = A_x
    xn = _layernorm(x, axis=-1)
    s = _A_ref(xn, A_wqkv, A_wo)
    g = _silu(_B_ref(xn, B_w1, B_w3, B_w2))
    return x + s * g
```

```asm
; @launch kernel=proj_kernel grid=(256,1,1) block=(512,1,1) lds=163840
; @launch kernel=attn_kernel grid=(256,1,1) block=(768,1,1) lds=138240
.amdgcn_target "amdgcn-amd-amdhsa--gfx950"
.text
.globl proj_kernel
.p2align 8
.type proj_kernel,@function
proj_kernel:
    s_cmp_ge_u32 s2, 255
    s_cbranch_scc1 proj_kernel_end
    s_load_dwordx16 s[4:19], s[0:1], 0
    s_load_dwordx4 s[20:23], s[0:1], 64
    v_lshrrev_b32 v1, 6, v0
    v_and_b32 v0, 63, v0
    s_and_b32 s3, s2, 7
    v_readfirstlane_b32 s46, v1
    s_lshl_b32 s3, s3, 5
    s_lshr_b32 s47, s2, 3
    s_add_u32 s3, s3, s47
    s_lshr_b32 s45, s3, 3
    s_and_b32 s44, s3, 7
    s_cmp_lt_u32 s3, 136
    s_cbranch_scc1 proj_kernel_dec
    s_sub_u32 s3, s3, 136
    s_mul_hi_u32 s45, s3, 0x24924925
    s_mul_i32 s47, s45, 7
    s_sub_u32 s44, s3, s47
    s_add_u32 s44, s44, 8
proj_kernel_dec:
    s_cmp_ge_u32 s45, 6
    s_cselect_b32 s47, 0xac0, 0
    s_cselect_b32 s3, 0, 0xc00
    s_add_u32 s47, s47, s3
    s_cmp_ge_u32 s46, 4
    s_cbranch_scc1 proj_kernel_loader
    s_waitcnt lgkmcnt(0)
    s_mov_b32 s36, s22
    s_and_b32 s37, s23, 0xffff
    s_mov_b32 s38, 25165824
    s_mov_b32 s39, 0x20000
    s_mov_b32 s92, s20
    s_and_b32 s93, s21, 0xffff
    s_mov_b32 s94, 256
    s_mov_b32 s95, 0x20000
    s_mov_b32 s24, s4
    s_and_b32 s25, s5, 0xffff
    s_mov_b32 s26, 2097152
    s_mov_b32 s27, 0x20000
    s_cmp_ge_u32 s45, 6
    s_cbranch_scc1 proj_kernel_wffnc
    s_lshl_b32 s3, s45, 9
    s_add_u32 s28, s6, s3
    s_addc_u32 s29, s7, 0
    s_sub_u32 s30, 1572864, s3
    s_add_u32 s32, s28, 256
    s_addc_u32 s33, s29, 0
    s_sub_u32 s34, s30, 256
    s_branch proj_kernel_wdonec
proj_kernel_wffnc:
    s_sub_u32 s3, s45, 6
    s_lshl_b32 s3, s3, 8
    s_add_u32 s28, s12, s3
    s_addc_u32 s29, s13, 0
    s_sub_u32 s30, 1409024, s3
    s_add_u32 s32, s14, s3
    s_addc_u32 s33, s15, 0
    s_mov_b32 s34, s30
proj_kernel_wdonec:
    s_and_b32 s29, s29, 0xffff
    s_and_b32 s33, s33, 0xffff
    s_mov_b32 s31, 0x20000
    s_mov_b32 s35, 0x20000
    s_cmp_eq_u32 s46, 3
    s_cbranch_scc1 proj_kernel_nost0
    s_cmp_eq_u32 s45, 16
    s_cbranch_scc1 proj_kernel_nost0
    s_mul_i32 s3, s44, 143
    s_mul_i32 s66, s45, 9
    s_add_u32 s3, s3, s66
    s_mul_i32 s66, s46, 3
    s_add_u32 s3, s3, s66
    s_lshl_b32 s3, s3, 10
    v_lshrrev_b32 v1, 4, v0
    v_min_u32 v1, 2, v1
    v_and_b32 v2, 15, v0
    v_lshlrev_b32 v2, 4, v2
    v_lshl_add_u32 v1, v1, 10, v2
    buffer_load_dwordx4 v[96:99], v1, s[24:27], s3 offen offset:0
    buffer_load_dwordx4 v[100:103], v1, s[24:27], s3 offen offset:256
    buffer_load_dwordx4 v[104:107], v1, s[24:27], s3 offen offset:512
    buffer_load_dwordx4 v[108:111], v1, s[24:27], s3 offen offset:768
proj_kernel_nost0:
    v_and_b32 v13, 15, v0
    v_lshrrev_b32 v14, 4, v0
    v_lshrrev_b32 v15, 1, v13
    v_xor_b32 v76, v14, v15
    v_lshlrev_b32 v76, 4, v76
    v_lshl_add_u32 v1, v13, 7, v76
    v_xor_b32 v2, 64, v1
    v_lshrrev_b32 v76, 2, v13
    v_and_b32 v77, 1, v14
    v_lshl_or_b32 v77, v77, 2, v76
    s_lshl_b32 s3, s46, 1
    v_xor_b32 v77, s3, v77
    v_lshlrev_b32 v77, 5, v77
    v_lshl_add_u32 v78, v14, 3, v76
    v_lshl_add_u32 v77, v78, 8, v77
    v_and_b32 v76, 3, v13
    v_lshl_add_u32 v3, v76, 3, v77
    v_xor_b32 v4, 32, v3
    v_add_u32 v5, 51200, v1
    v_add_u32 v6, 51200, v2
    v_add_u32 v7, 51200, v3
    v_add_u32 v8, 51200, v4
    v_add_u32 v9, 102400, v1
    v_add_u32 v10, 102400, v2
    v_add_u32 v11, 102400, v3
    v_add_u32 v12, 102400, v4
    s_cmp_eq_u32 s46, 3
    s_cbranch_scc1 proj_kernel_nost1
    s_cmp_eq_u32 s45, 16
    s_cbranch_scc1 proj_kernel_nost1
    s_mov_b32 s66, 0xffff0000
    s_mov_b32 s3, 0x3b000000
    s_mov_b32 s67, 0x3727c5ac
    s_waitcnt vmcnt(0)
    v_lshlrev_b32 v112, 16, v96
    v_and_b32 v113, s66, v96
    v_lshlrev_b32 v114, 16, v97
    v_and_b32 v115, s66, v97
    v_lshlrev_b32 v116, 16, v98
    v_and_b32 v117, s66, v98
    v_lshlrev_b32 v118, 16, v99
    v_and_b32 v119, s66, v99
    v_lshlrev_b32 v120, 16, v100
    v_and_b32 v121, s66, v100
    v_lshlrev_b32 v122, 16, v101
    v_and_b32 v123, s66, v101
    v_lshlrev_b32 v124, 16, v102
    v_and_b32 v125, s66, v102
    v_lshlrev_b32 v126, 16, v103
    v_and_b32 v127, s66, v103
    v_lshlrev_b32 v128, 16, v104
    v_and_b32 v129, s66, v104
    v_lshlrev_b32 v130, 16, v105
    v_and_b32 v131, s66, v105
    v_lshlrev_b32 v132, 16, v106
    v_and_b32 v133, s66, v106
    v_lshlrev_b32 v134, 16, v107
    v_and_b32 v135, s66, v107
    v_lshlrev_b32 v136, 16, v108
    v_and_b32 v137, s66, v108
    v_lshlrev_b32 v138, 16, v109
    v_and_b32 v139, s66, v109
    v_lshlrev_b32 v140, 16, v110
    v_and_b32 v141, s66, v110
    v_lshlrev_b32 v142, 16, v111
    v_and_b32 v143, s66, v111
    v_pk_mul_f32 v[144:145], v[112:113], v[112:113]
    v_pk_mul_f32 v[146:147], v[114:115], v[114:115]
    v_pk_mul_f32 v[148:149], v[116:117], v[116:117]
    v_pk_mul_f32 v[150:151], v[118:119], v[118:119]
    v_pk_fma_f32 v[144:145], v[120:121], v[120:121], v[144:145]
    v_pk_add_f32 v[112:113], v[112:113], v[120:121]
    v_pk_fma_f32 v[146:147], v[122:123], v[122:123], v[146:147]
    v_pk_add_f32 v[114:115], v[114:115], v[122:123]
    v_pk_fma_f32 v[148:149], v[124:125], v[124:125], v[148:149]
    v_pk_add_f32 v[116:117], v[116:117], v[124:125]
    v_pk_fma_f32 v[150:151], v[126:127], v[126:127], v[150:151]
    v_pk_add_f32 v[118:119], v[118:119], v[126:127]
    v_pk_fma_f32 v[144:145], v[128:129], v[128:129], v[144:145]
    v_pk_add_f32 v[112:113], v[112:113], v[128:129]
    v_pk_fma_f32 v[146:147], v[130:131], v[130:131], v[146:147]
    v_pk_add_f32 v[114:115], v[114:115], v[130:131]
    v_pk_fma_f32 v[148:149], v[132:133], v[132:133], v[148:149]
    v_pk_add_f32 v[116:117], v[116:117], v[132:133]
    v_pk_fma_f32 v[150:151], v[134:135], v[134:135], v[150:151]
    v_pk_add_f32 v[118:119], v[118:119], v[134:135]
    v_pk_fma_f32 v[144:145], v[136:137], v[136:137], v[144:145]
    v_pk_add_f32 v[112:113], v[112:113], v[136:137]
    v_pk_fma_f32 v[146:147], v[138:139], v[138:139], v[146:147]
    v_pk_add_f32 v[114:115], v[114:115], v[138:139]
    v_pk_fma_f32 v[148:149], v[140:141], v[140:141], v[148:149]
    v_pk_add_f32 v[116:117], v[116:117], v[140:141]
    v_pk_fma_f32 v[150:151], v[142:143], v[142:143], v[150:151]
    v_pk_add_f32 v[118:119], v[118:119], v[142:143]
    v_pk_add_f32 v[112:113], v[112:113], v[114:115]
    v_pk_add_f32 v[116:117], v[116:117], v[118:119]
    v_pk_add_f32 v[144:145], v[144:145], v[146:147]
    v_pk_add_f32 v[148:149], v[148:149], v[150:151]
    v_pk_add_f32 v[112:113], v[112:113], v[116:117]
    v_pk_add_f32 v[144:145], v[144:145], v[148:149]
    v_add_f32 v96, v112, v113
    v_add_f32 v97, v144, v145
    s_nop 0
    v_add_f32_dpp v96, v96, v96 quad_perm:[1,0,3,2] row_mask:0xf bank_mask:0xf
    v_add_f32_dpp v97, v97, v97 quad_perm:[1,0,3,2] row_mask:0xf bank_mask:0xf
    s_nop 0
    v_add_f32_dpp v96, v96, v96 quad_perm:[2,3,0,1] row_mask:0xf bank_mask:0xf
    v_add_f32_dpp v97, v97, v97 quad_perm:[2,3,0,1] row_mask:0xf bank_mask:0xf
    s_nop 0
    v_add_f32_dpp v96, v96, v96 row_half_mirror row_mask:0xf bank_mask:0xf
    v_add_f32_dpp v97, v97, v97 row_half_mirror row_mask:0xf bank_mask:0xf
    s_nop 0
    v_add_f32_dpp v96, v96, v96 row_mirror row_mask:0xf bank_mask:0xf
    v_add_f32_dpp v97, v97, v97 row_mirror row_mask:0xf bank_mask:0xf
    v_mul_f32 v96, s3, v96
    v_mul_f32 v97, s3, v97
    v_fma_f32 v97, -v96, v96, v97
    v_max_f32 v97, 0, v97
    v_cvt_pk_bf16_f32 v98, v96, v97
    v_lshlrev_b32 v96, 16, v98
    v_and_b32 v97, s66, v98
    v_add_f32 v97, s67, v97
    v_cvt_pk_bf16_f32 v98, v97, v97
    v_and_b32 v98, s66, v98
    v_sqrt_f32 v98, v98
    s_mul_i32 s3, s44, 48
    s_mul_i32 s67, s45, 3
    v_cvt_pk_bf16_f32 v98, v98, v98
    v_and_b32 v98, s66, v98
    v_rcp_f32 v97, v98
    s_add_u32 s3, s3, s67
    s_add_u32 s3, s3, s46
    s_lshl_b32 s3, s3, 7
    s_add_u32 s3, s3, 19922944
    v_lshlrev_b32 v98, 1, v0
    s_mov_b32 exec_lo, 0x11111111
    s_mov_b32 exec_hi, 0x11111111
    buffer_store_dwordx2 v[96:97], v98, s[36:39], s3 offen sc1
    s_mov_b64 exec, -1
proj_kernel_nost1:
    s_barrier
    ds_read_b64_tr_b16 v[44:45], v3 offset:18432
    ds_read_b64_tr_b16 v[46:47], v3 offset:19456
    ds_read_b64_tr_b16 v[48:49], v4 offset:18432
    ds_read_b64_tr_b16 v[50:51], v4 offset:19456
    ds_read_b64_tr_b16 v[52:53], v3 offset:34816
    ds_read_b64_tr_b16 v[54:55], v3 offset:35840
    ds_read_b64_tr_b16 v[56:57], v4 offset:34816
    ds_read_b64_tr_b16 v[58:59], v4 offset:35840
    ds_read_b128 v[16:19], v1 offset:0
    ds_read_b128 v[20:23], v1 offset:2048
    ds_read_b128 v[24:27], v1 offset:4096
    s_waitcnt lgkmcnt(2)
    v_mfma_f32_16x16x32_bf16 v[96:99], v[44:47], v[16:19], 0
    ds_read_b128 v[28:31], v1 offset:6144
    v_mfma_f32_16x16x32_bf16 v[100:103], v[48:51], v[16:19], 0
    ds_read_b128 v[32:35], v1 offset:8192
    v_mfma_f32_16x16x32_bf16 v[104:107], v[52:55], v[16:19], 0
    v_mfma_f32_16x16x32_bf16 v[108:111], v[56:59], v[16:19], 0
    s_waitcnt lgkmcnt(3)
    v_mfma_f32_16x16x32_bf16 v[112:115], v[44:47], v[20:23], 0
    ds_read_b128 v[36:39], v1 offset:10240
    v_mfma_f32_16x16x32_bf16 v[116:119], v[48:51], v[20:23], 0
    ds_read_b128 v[40:43], v1 offset:12288
    v_mfma_f32_16x16x32_bf16 v[120:123], v[52:55], v[20:23], 0
    v_mfma_f32_16x16x32_bf16 v[124:127], v[56:59], v[20:23], 0
    s_waitcnt lgkmcnt(4)
    v_mfma_f32_16x16x32_bf16 v[128:131], v[44:47], v[24:27], 0
    ds_read_b128 v[76:79], v1 offset:14336
    ds_read_b128 v[80:83], v1 offset:16384
    v_mfma_f32_16x16x32_bf16 v[132:135], v[48:51], v[24:27], 0
    ds_read_b64_tr_b16 v[60:61], v3 offset:26624
    ds_read_b64_tr_b16 v[62:63], v3 offset:27648
    v_mfma_f32_16x16x32_bf16 v[136:139], v[52:55], v[24:27], 0
    ds_read_b64_tr_b16 v[64:65], v4 offset:26624
    ds_read_b64_tr_b16 v[66:67], v4 offset:27648
    v_mfma_f32_16x16x32_bf16 v[140:143], v[56:59], v[24:27], 0
    ds_read_b64_tr_b16 v[68:69], v3 offset:43008
    ds_read_b64_tr_b16 v[70:71], v3 offset:44032
    s_waitcnt lgkmcnt(11)
    v_mfma_f32_16x16x32_bf16 v[144:147], v[44:47], v[28:31], 0
    ds_read_b64_tr_b16 v[72:73], v4 offset:43008
    v_mfma_f32_16x16x32_bf16 v[148:151], v[48:51], v[28:31], 0
    ds_read_b64_tr_b16 v[74:75], v4 offset:44032
    v_mfma_f32_16x16x32_bf16 v[152:155], v[52:55], v[28:31], 0
    ds_read_b128 v[84:87], v2 offset:0
    v_mfma_f32_16x16x32_bf16 v[156:159], v[56:59], v[28:31], 0
    ds_read_b128 v[88:91], v2 offset:2048
    s_waitcnt lgkmcnt(14)
    v_mfma_f32_16x16x32_bf16 v[160:163], v[44:47], v[32:35], 0
    ds_read_b128 v[92:95], v2 offset:4096
    v_mfma_f32_16x16x32_bf16 v[164:167], v[48:51], v[32:35], 0
    ds_read_b128 v[16:19], v2 offset:6144
    v_mfma_f32_16x16x32_bf16 v[168:171], v[52:55], v[32:35], 0
    v_mfma_f32_16x16x32_bf16 v[172:175], v[56:59], v[32:35], 0
    s_waitcnt lgkmcnt(15)
    v_mfma_f32_16x16x32_bf16 v[176:179], v[44:47], v[36:39], 0
    ds_read_b128 v[20:23], v2 offset:8192
    v_mfma_f32_16x16x32_bf16 v[180:183], v[48:51], v[36:39], 0
    ds_read_b128 v[24:27], v2 offset:10240
    v_mfma_f32_16x16x32_bf16 v[184:187], v[52:55], v[36:39], 0
    v_mfma_f32_16x16x32_bf16 v[188:191], v[56:59], v[36:39], 0
    s_waitcnt lgkmcnt(15)
    v_mfma_f32_16x16x32_bf16 v[192:195], v[44:47], v[40:43], 0
    ds_read_b128 v[28:31], v2 offset:12288
    v_mfma_f32_16x16x32_bf16 v[196:199], v[48:51], v[40:43], 0
    v_mfma_f32_16x16x32_bf16 v[200:203], v[52:55], v[40:43], 0
    v_mfma_f32_16x16x32_bf16 v[204:207], v[56:59], v[40:43], 0
    v_mfma_f32_16x16x32_bf16 v[208:211], v[44:47], v[76:79], 0
    ds_read_b128 v[32:35], v2 offset:14336
    v_mfma_f32_16x16x32_bf16 v[212:215], v[48:51], v[76:79], 0
    v_mfma_f32_16x16x32_bf16 v[216:219], v[52:55], v[76:79], 0
    v_mfma_f32_16x16x32_bf16 v[220:223], v[56:59], v[76:79], 0
    s_waitcnt lgkmcnt(15)
    v_mfma_f32_16x16x32_bf16 v[224:227], v[44:47], v[80:83], 0
    ds_read_b128 v[36:39], v2 offset:16384
    v_mfma_f32_16x16x32_bf16 v[228:231], v[48:51], v[80:83], 0
    v_mfma_f32_16x16x32_bf16 v[232:235], v[52:55], v[80:83], 0
    v_mfma_f32_16x16x32_bf16 v[236:239], v[56:59], v[80:83], 0
    s_waitcnt lgkmcnt(8)
    v_mfma_f32_16x16x32_bf16 v[96:99], v[60:63], v[84:87], v[96:99]
    v_mfma_f32_16x16x32_bf16 v[100:103], v[64:67], v[84:87], v[100:103]
    v_mfma_f32_16x16x32_bf16 v[104:107], v[68:71], v[84:87], v[104:107]
    v_mfma_f32_16x16x32_bf16 v[108:111], v[72:75], v[84:87], v[108:111]
    s_waitcnt lgkmcnt(0)
    s_barrier
    v_mfma_f32_16x16x32_bf16 v[112:115], v[60:63], v[88:91], v[112:115]
    ds_read_b64_tr_b16 v[44:45], v7 offset:18432
    ds_read_b64_tr_b16 v[46:47], v7 offset:19456
    v_mfma_f32_16x16x32_bf16 v[116:119], v[64:67], v[88:91], v[116:119]
    ds_read_b64_tr_b16 v[48:49], v8 offset:18432
    ds_read_b64_tr_b16 v[50:51], v8 offset:19456
    v_mfma_f32_16x16x32_bf16 v[120:123], v[68:71], v[88:91], v[120:123]
    ds_read_b64_tr_b16 v[52:53], v7 offset:34816
    ds_read_b64_tr_b16 v[54:55], v7 offset:35840
    v_mfma_f32_16x16x32_bf16 v[124:127], v[72:75], v[88:91], v[124:127]
    ds_read_b64_tr_b16 v[56:57], v8 offset:34816
    ds_read_b64_tr_b16 v[58:59], v8 offset:35840
    v_mfma_f32_16x16x32_bf16 v[128:131], v[60:63], v[92:95], v[128:131]
    ds_read_b128 v[40:43], v5 offset:0
    v_mfma_f32_16x16x32_bf16 v[132:135], v[64:67], v[92:95], v[132:135]
    ds_read_b128 v[76:79], v5 offset:2048
    v_mfma_f32_16x16x32_bf16 v[136:139], v[68:71], v[92:95], v[136:139]
    ds_read_b128 v[80:83], v5 offset:4096
    v_mfma_f32_16x16x32_bf16 v[140:143], v[72:75], v[92:95], v[140:143]
    v_mfma_f32_16x16x32_bf16 v[144:147], v[60:63], v[16:19], v[144:147]
    ds_read_b128 v[84:87], v5 offset:6144
    v_mfma_f32_16x16x32_bf16 v[148:151], v[64:67], v[16:19], v[148:151]
    v_mfma_f32_16x16x32_bf16 v[152:155], v[68:71], v[16:19], v[152:155]
    v_mfma_f32_16x16x32_bf16 v[156:159], v[72:75], v[16:19], v[156:159]
    v_mfma_f32_16x16x32_bf16 v[160:163], v[60:63], v[20:23], v[160:163]
    ds_read_b128 v[88:91], v5 offset:8192
    v_mfma_f32_16x16x32_bf16 v[164:167], v[64:67], v[20:23], v[164:167]
    v_mfma_f32_16x16x32_bf16 v[168:171], v[68:71], v[20:23], v[168:171]
    v_mfma_f32_16x16x32_bf16 v[172:175], v[72:75], v[20:23], v[172:175]
    v_mfma_f32_16x16x32_bf16 v[176:179], v[60:63], v[24:27], v[176:179]
    ds_read_b128 v[92:95], v5 offset:10240
    v_mfma_f32_16x16x32_bf16 v[180:183], v[64:67], v[24:27], v[180:183]
    v_mfma_f32_16x16x32_bf16 v[184:187], v[68:71], v[24:27], v[184:187]
    v_mfma_f32_16x16x32_bf16 v[188:191], v[72:75], v[24:27], v[188:191]
    v_mfma_f32_16x16x32_bf16 v[192:195], v[60:63], v[28:31], v[192:195]
    ds_read_b128 v[16:19], v5 offset:12288
    v_mfma_f32_16x16x32_bf16 v[196:199], v[64:67], v[28:31], v[196:199]
    v_mfma_f32_16x16x32_bf16 v[200:203], v[68:71], v[28:31], v[200:203]
    v_mfma_f32_16x16x32_bf16 v[204:207], v[72:75], v[28:31], v[204:207]
    v_mfma_f32_16x16x32_bf16 v[208:211], v[60:63], v[32:35], v[208:211]
    ds_read_b128 v[20:23], v5 offset:14336
    v_mfma_f32_16x16x32_bf16 v[212:215], v[64:67], v[32:35], v[212:215]
    v_mfma_f32_16x16x32_bf16 v[216:219], v[68:71], v[32:35], v[216:219]
    v_mfma_f32_16x16x32_bf16 v[220:223], v[72:75], v[32:35], v[220:223]
    v_mfma_f32_16x16x32_bf16 v[224:227], v[60:63], v[36:39], v[224:227]
    ds_read_b128 v[24:27], v5 offset:16384
    v_mfma_f32_16x16x32_bf16 v[228:231], v[64:67], v[36:39], v[228:231]
    v_mfma_f32_16x16x32_bf16 v[232:235], v[68:71], v[36:39], v[232:235]
    v_mfma_f32_16x16x32_bf16 v[236:239], v[72:75], v[36:39], v[236:239]
    s_waitcnt lgkmcnt(8)
    v_mfma_f32_16x16x32_bf16 v[96:99], v[44:47], v[40:43], v[96:99]
    ds_read_b128 v[28:31], v6 offset:0
    v_mfma_f32_16x16x32_bf16 v[100:103], v[48:51], v[40:43], v[100:103]
    v_mfma_f32_16x16x32_bf16 v[104:107], v[52:55], v[40:43], v[104:107]
    v_mfma_f32_16x16x32_bf16 v[108:111], v[56:59], v[40:43], v[108:111]
    s_waitcnt lgkmcnt(8)
    v_mfma_f32_16x16x32_bf16 v[112:115], v[44:47], v[76:79], v[112:115]
    ds_read_b128 v[32:35], v6 offset:2048
    v_mfma_f32_16x16x32_bf16 v[116:119], v[48:51], v[76:79], v[116:119]
    v_mfma_f32_16x16x32_bf16 v[120:123], v[52:55], v[76:79], v[120:123]
    v_mfma_f32_16x16x32_bf16 v[124:127], v[56:59], v[76:79], v[124:127]
    s_waitcnt lgkmcnt(8)
    v_mfma_f32_16x16x32_bf16 v[128:131], v[44:47], v[80:83], v[128:131]
    ds_read_b128 v[36:39], v6 offset:4096
    ds_read_b64_tr_b16 v[60:61], v7 offset:26624
    v_mfma_f32_16x16x32_bf16 v[132:135], v[48:51], v[80:83], v[132:135]
    ds_read_b64_tr_b16 v[62:63], v7 offset:27648
    ds_read_b64_tr_b16 v[64:65], v8 offset:26624
    v_mfma_f32_16x16x32_bf16 v[136:139], v[52:55], v[80:83], v[136:139]
    ds_read_b64_tr_b16 v[66:67], v8 offset:27648
    ds_read_b64_tr_b16 v[68:69], v7 offset:43008
    v_mfma_f32_16x16x32_bf16 v[140:143], v[56:59], v[80:83], v[140:143]
    ds_read_b64_tr_b16 v[70:71], v7 offset:44032
    ds_read_b64_tr_b16 v[72:73], v8 offset:43008
    s_waitcnt lgkmcnt(15)
    v_mfma_f32_16x16x32_bf16 v[144:147], v[44:47], v[84:87], v[144:147]
    ds_read_b64_tr_b16 v[74:75], v8 offset:44032
    v_mfma_f32_16x16x32_bf16 v[148:151], v[48:51], v[84:87], v[148:151]
    ds_read_b128 v[40:43], v6 offset:6144
    v_mfma_f32_16x16x32_bf16 v[152:155], v[52:55], v[84:87], v[152:155]
    v_mfma_f32_16x16x32_bf16 v[156:159], v[56:59], v[84:87], v[156:159]
    s_waitcnt lgkmcnt(15)
    v_mfma_f32_16x16x32_bf16 v[160:163], v[44:47], v[88:91], v[160:163]
    ds_read_b128 v[76:79], v6 offset:8192
    v_mfma_f32_16x16x32_bf16 v[164:167], v[48:51], v[88:91], v[164:167]
    v_mfma_f32_16x16x32_bf16 v[168:171], v[52:55], v[88:91], v[168:171]
    v_mfma_f32_16x16x32_bf16 v[172:175], v[56:59], v[88:91], v[172:175]
    v_mfma_f32_16x16x32_bf16 v[176:179], v[44:47], v[92:95], v[176:179]
    ds_read_b128 v[80:83], v6 offset:10240
    v_mfma_f32_16x16x32_bf16 v[180:183], v[48:51], v[92:95], v[180:183]
    v_mfma_f32_16x16x32_bf16 v[184:187], v[52:55], v[92:95], v[184:187]
    v_mfma_f32_16x16x32_bf16 v[188:191], v[56:59], v[92:95], v[188:191]
    s_waitcnt lgkmcnt(15)
    v_mfma_f32_16x16x32_bf16 v[192:195], v[44:47], v[16:19], v[192:195]
    ds_read_b128 v[84:87], v6 offset:12288
    v_mfma_f32_16x16x32_bf16 v[196:199], v[48:51], v[16:19], v[196:199]
    v_mfma_f32_16x16x32_bf16 v[200:203], v[52:55], v[16:19], v[200:203]
    v_mfma_f32_16x16x32_bf16 v[204:207], v[56:59], v[16:19], v[204:207]
    v_mfma_f32_16x16x32_bf16 v[208:211], v[44:47], v[20:23], v[208:211]
    ds_read_b128 v[88:91], v6 offset:14336
    v_mfma_f32_16x16x32_bf16 v[212:215], v[48:51], v[20:23], v[212:215]
    v_mfma_f32_16x16x32_bf16 v[216:219], v[52:55], v[20:23], v[216:219]
    v_mfma_f32_16x16x32_bf16 v[220:223], v[56:59], v[20:23], v[220:223]
    s_waitcnt lgkmcnt(15)
    v_mfma_f32_16x16x32_bf16 v[224:227], v[44:47], v[24:27], v[224:227]
    ds_read_b128 v[92:95], v6 offset:16384
    v_mfma_f32_16x16x32_bf16 v[228:231], v[48:51], v[24:27], v[228:231]
    v_mfma_f32_16x16x32_bf16 v[232:235], v[52:55], v[24:27], v[232:235]
    v_mfma_f32_16x16x32_bf16 v[236:239], v[56:59], v[24:27], v[236:239]
    s_waitcnt lgkmcnt(6)
    v_mfma_f32_16x16x32_bf16 v[96:99], v[60:63], v[28:31], v[96:99]
    v_mfma_f32_16x16x32_bf16 v[100:103], v[64:67], v[28:31], v[100:103]
    v_mfma_f32_16x16x32_bf16 v[104:107], v[68:71], v[28:31], v[104:107]
    v_mfma_f32_16x16x32_bf16 v[108:111], v[72:75], v[28:31], v[108:111]
    s_waitcnt lgkmcnt(0) vmcnt(0)
    s_barrier
    v_mfma_f32_16x16x32_bf16 v[112:115], v[60:63], v[32:35], v[112:115]
    ds_read_b64_tr_b16 v[44:45], v11 offset:18432
    ds_read_b64_tr_b16 v[46:47], v11 offset:19456
    v_mfma_f32_16x16x32_bf16 v[116:119], v[64:67], v[32:35], v[116:119]
    ds_read_b64_tr_b16 v[48:49], v12 offset:18432
    ds_read_b64_tr_b16 v[50:51], v12 offset:19456
    v_mfma_f32_16x16x32_bf16 v[120:123], v[68:71], v[32:35], v[120:123]
    ds_read_b64_tr_b16 v[52:53], v11 offset:34816
    ds_read_b64_tr_b16 v[54:55], v11 offset:35840
    v_mfma_f32_16x16x32_bf16 v[124:127], v[72:75], v[32:35], v[124:127]
    ds_read_b64_tr_b16 v[56:57], v12 offset:34816
    ds_read_b64_tr_b16 v[58:59], v12 offset:35840
    v_mfma_f32_16x16x32_bf16 v[128:131], v[60:63], v[36:39], v[128:131]
    ds_read_b128 v[16:19], v9 offset:0
    v_mfma_f32_16x16x32_bf16 v[132:135], v[64:67], v[36:39], v[132:135]
    ds_read_b128 v[20:23], v9 offset:2048
    v_mfma_f32_16x16x32_bf16 v[136:139], v[68:71], v[36:39], v[136:139]
    ds_read_b128 v[24:27], v9 offset:4096
    v_mfma_f32_16x16x32_bf16 v[140:143], v[72:75], v[36:39], v[140:143]
    v_mfma_f32_16x16x32_bf16 v[144:147], v[60:63], v[40:43], v[144:147]
    ds_read_b128 v[28:31], v9 offset:6144
    v_mfma_f32_16x16x32_bf16 v[148:151], v[64:67], v[40:43], v[148:151]
    v_mfma_f32_16x16x32_bf16 v[152:155], v[68:71], v[40:43], v[152:155]
    v_mfma_f32_16x16x32_bf16 v[156:159], v[72:75], v[40:43], v[156:159]
    v_mfma_f32_16x16x32_bf16 v[160:163], v[60:63], v[76:79], v[160:163]
    ds_read_b128 v[32:35], v9 offset:8192
    v_mfma_f32_16x16x32_bf16 v[164:167], v[64:67], v[76:79], v[164:167]
    v_mfma_f32_16x16x32_bf16 v[168:171], v[68:71], v[76:79], v[168:171]
    v_mfma_f32_16x16x32_bf16 v[172:175], v[72:75], v[76:79], v[172:175]
    v_mfma_f32_16x16x32_bf16 v[176:179], v[60:63], v[80:83], v[176:179]
    ds_read_b128 v[36:39], v9 offset:10240
    v_mfma_f32_16x16x32_bf16 v[180:183], v[64:67], v[80:83], v[180:183]
    v_mfma_f32_16x16x32_bf16 v[184:187], v[68:71], v[80:83], v[184:187]
    v_mfma_f32_16x16x32_bf16 v[188:191], v[72:75], v[80:83], v[188:191]
    v_mfma_f32_16x16x32_bf16 v[192:195], v[60:63], v[84:87], v[192:195]
    ds_read_b128 v[40:43], v9 offset:12288
    v_mfma_f32_16x16x32_bf16 v[196:199], v[64:67], v[84:87], v[196:199]
    v_mfma_f32_16x16x32_bf16 v[200:203], v[68:71], v[84:87], v[200:203]
    v_mfma_f32_16x16x32_bf16 v[204:207], v[72:75], v[84:87], v[204:207]
    v_mfma_f32_16x16x32_bf16 v[208:211], v[60:63], v[88:91], v[208:211]
    ds_read_b128 v[76:79], v9 offset:14336
    v_mfma_f32_16x16x32_bf16 v[212:215], v[64:67], v[88:91], v[212:215]
    v_mfma_f32_16x16x32_bf16 v[216:219], v[68:71], v[88:91], v[216:219]
    v_mfma_f32_16x16x32_bf16 v[220:223], v[72:75], v[88:91], v[220:223]
    v_mfma_f32_16x16x32_bf16 v[224:227], v[60:63], v[92:95], v[224:227]
    ds_read_b128 v[80:83], v9 offset:16384
    v_mfma_f32_16x16x32_bf16 v[228:231], v[64:67], v[92:95], v[228:231]
    v_mfma_f32_16x16x32_bf16 v[232:235], v[68:71], v[92:95], v[232:235]
    v_mfma_f32_16x16x32_bf16 v[236:239], v[72:75], v[92:95], v[236:239]
    s_waitcnt lgkmcnt(8)
    v_mfma_f32_16x16x32_bf16 v[96:99], v[44:47], v[16:19], v[96:99]
    ds_read_b128 v[84:87], v10 offset:0
    v_mfma_f32_16x16x32_bf16 v[100:103], v[48:51], v[16:19], v[100:103]
    v_mfma_f32_16x16x32_bf16 v[104:107], v[52:55], v[16:19], v[104:107]
    v_mfma_f32_16x16x32_bf16 v[108:111], v[56:59], v[16:19], v[108:111]
    s_waitcnt lgkmcnt(8)
    v_mfma_f32_16x16x32_bf16 v[112:115], v[44:47], v[20:23], v[112:115]
    ds_read_b128 v[88:91], v10 offset:2048
    v_mfma_f32_16x16x32_bf16 v[116:119], v[48:51], v[20:23], v[116:119]
    v_mfma_f32_16x16x32_bf16 v[120:123], v[52:55], v[20:23], v[120:123]
    v_mfma_f32_16x16x32_bf16 v[124:127], v[56:59], v[20:23], v[124:127]
    s_waitcnt lgkmcnt(8)
    v_mfma_f32_16x16x32_bf16 v[128:131], v[44:47], v[24:27], v[128:131]
    ds_read_b128 v[92:95], v10 offset:4096
    ds_read_b64_tr_b16 v[60:61], v11 offset:26624
    v_mfma_f32_16x16x32_bf16 v[132:135], v[48:51], v[24:27], v[132:135]
    ds_read_b64_tr_b16 v[62:63], v11 offset:27648
    ds_read_b64_tr_b16 v[64:65], v12 offset:26624
    v_mfma_f32_16x16x32_bf16 v[136:139], v[52:55], v[24:27], v[136:139]
    ds_read_b64_tr_b16 v[66:67], v12 offset:27648
    ds_read_b64_tr_b16 v[68:69], v11 offset:43008
    v_mfma_f32_16x16x32_bf16 v[140:143], v[56:59], v[24:27], v[140:143]
    ds_read_b64_tr_b16 v[70:71], v11 offset:44032
    ds_read_b64_tr_b16 v[72:73], v12 offset:43008
    s_waitcnt lgkmcnt(15)
    v_mfma_f32_16x16x32_bf16 v[144:147], v[44:47], v[28:31], v[144:147]
    ds_read_b64_tr_b16 v[74:75], v12 offset:44032
    v_mfma_f32_16x16x32_bf16 v[148:151], v[48:51], v[28:31], v[148:151]
    ds_read_b128 v[16:19], v10 offset:6144
    v_mfma_f32_16x16x32_bf16 v[152:155], v[52:55], v[28:31], v[152:155]
    v_mfma_f32_16x16x32_bf16 v[156:159], v[56:59], v[28:31], v[156:159]
    s_waitcnt lgkmcnt(15)
    v_mfma_f32_16x16x32_bf16 v[160:163], v[44:47], v[32:35], v[160:163]
    ds_read_b128 v[20:23], v10 offset:8192
    v_mfma_f32_16x16x32_bf16 v[164:167], v[48:51], v[32:35], v[164:167]
    v_mfma_f32_16x16x32_bf16 v[168:171], v[52:55], v[32:35], v[168:171]
    v_mfma_f32_16x16x32_bf16 v[172:175], v[56:59], v[32:35], v[172:175]
    v_mfma_f32_16x16x32_bf16 v[176:179], v[44:47], v[36:39], v[176:179]
    ds_read_b128 v[24:27], v10 offset:10240
    v_mfma_f32_16x16x32_bf16 v[180:183], v[48:51], v[36:39], v[180:183]
    v_mfma_f32_16x16x32_bf16 v[184:187], v[52:55], v[36:39], v[184:187]
    v_mfma_f32_16x16x32_bf16 v[188:191], v[56:59], v[36:39], v[188:191]
    s_waitcnt lgkmcnt(15)
    v_mfma_f32_16x16x32_bf16 v[192:195], v[44:47], v[40:43], v[192:195]
    ds_read_b128 v[28:31], v10 offset:12288
    v_mfma_f32_16x16x32_bf16 v[196:199], v[48:51], v[40:43], v[196:199]
    v_mfma_f32_16x16x32_bf16 v[200:203], v[52:55], v[40:43], v[200:203]
    v_mfma_f32_16x16x32_bf16 v[204:207], v[56:59], v[40:43], v[204:207]
    v_mfma_f32_16x16x32_bf16 v[208:211], v[44:47], v[76:79], v[208:211]
    ds_read_b128 v[32:35], v10 offset:14336
    v_mfma_f32_16x16x32_bf16 v[212:215], v[48:51], v[76:79], v[212:215]
    v_mfma_f32_16x16x32_bf16 v[216:219], v[52:55], v[76:79], v[216:219]
    v_mfma_f32_16x16x32_bf16 v[220:223], v[56:59], v[76:79], v[220:223]
    s_waitcnt lgkmcnt(15)
    v_mfma_f32_16x16x32_bf16 v[224:227], v[44:47], v[80:83], v[224:227]
    ds_read_b128 v[36:39], v10 offset:16384
    v_mfma_f32_16x16x32_bf16 v[228:231], v[48:51], v[80:83], v[228:231]
    v_mfma_f32_16x16x32_bf16 v[232:235], v[52:55], v[80:83], v[232:235]
    v_mfma_f32_16x16x32_bf16 v[236:239], v[56:59], v[80:83], v[236:239]
    s_waitcnt lgkmcnt(6)
    v_mfma_f32_16x16x32_bf16 v[96:99], v[60:63], v[84:87], v[96:99]
    v_mfma_f32_16x16x32_bf16 v[100:103], v[64:67], v[84:87], v[100:103]
    v_mfma_f32_16x16x32_bf16 v[104:107], v[68:71], v[84:87], v[104:107]
    v_mfma_f32_16x16x32_bf16 v[108:111], v[72:75], v[84:87], v[108:111]
    s_waitcnt lgkmcnt(0)
    s_barrier
    v_mfma_f32_16x16x32_bf16 v[112:115], v[60:63], v[88:91], v[112:115]
    ds_read_b64_tr_b16 v[44:45], v3 offset:18432
    ds_read_b64_tr_b16 v[46:47], v3 offset:19456
    v_mfma_f32_16x16x32_bf16 v[116:119], v[64:67], v[88:91], v[116:119]
    ds_read_b64_tr_b16 v[48:49], v4 offset:18432
    ds_read_b64_tr_b16 v[50:51], v4 offset:19456
    v_mfma_f32_16x16x32_bf16 v[120:123], v[68:71], v[88:91], v[120:123]
    ds_read_b64_tr_b16 v[52:53], v3 offset:34816
    ds_read_b64_tr_b16 v[54:55], v3 offset:35840
    v_mfma_f32_16x16x32_bf16 v[124:127], v[72:75], v[88:91], v[124:127]
    ds_read_b64_tr_b16 v[56:57], v4 offset:34816
    ds_read_b64_tr_b16 v[58:59], v4 offset:35840
    v_mfma_f32_16x16x32_bf16 v[128:131], v[60:63], v[92:95], v[128:131]
    ds_read_b128 v[40:43], v1 offset:0
    v_mfma_f32_16x16x32_bf16 v[132:135], v[64:67], v[92:95], v[132:135]
    ds_read_b128 v[76:79], v1 offset:2048
    v_mfma_f32_16x16x32_bf16 v[136:139], v[68:71], v[92:95], v[136:139]
    ds_read_b128 v[80:83], v1 offset:4096
    v_mfma_f32_16x16x32_bf16 v[140:143], v[72:75], v[92:95], v[140:143]
    v_mfma_f32_16x16x32_bf16 v[144:147], v[60:63], v[16:19], v[144:147]
    ds_read_b128 v[84:87], v1 offset:6144
    v_mfma_f32_16x16x32_bf16 v[148:151], v[64:67], v[16:19], v[148:151]
    v_mfma_f32_16x16x32_bf16 v[152:155], v[68:71], v[16:19], v[152:155]
    v_mfma_f32_16x16x32_bf16 v[156:159], v[72:75], v[16:19], v[156:159]
    v_mfma_f32_16x16x32_bf16 v[160:163], v[60:63], v[20:23], v[160:163]
    ds_read_b128 v[88:91], v1 offset:8192
    v_mfma_f32_16x16x32_bf16 v[164:167], v[64:67], v[20:23], v[164:167]
    v_mfma_f32_16x16x32_bf16 v[168:171], v[68:71], v[20:23], v[168:171]
    v_mfma_f32_16x16x32_bf16 v[172:175], v[72:75], v[20:23], v[172:175]
    v_mfma_f32_16x16x32_bf16 v[176:179], v[60:63], v[24:27], v[176:179]
    ds_read_b128 v[92:95], v1 offset:10240
    v_mfma_f32_16x16x32_bf16 v[180:183], v[64:67], v[24:27], v[180:183]
    v_mfma_f32_16x16x32_bf16 v[184:187], v[68:71], v[24:27], v[184:187]
    v_mfma_f32_16x16x32_bf16 v[188:191], v[72:75], v[24:27], v[188:191]
    v_mfma_f32_16x16x32_bf16 v[192:195], v[60:63], v[28:31], v[192:195]
    ds_read_b128 v[16:19], v1 offset:12288
    v_mfma_f32_16x16x32_bf16 v[196:199], v[64:67], v[28:31], v[196:199]
    v_mfma_f32_16x16x32_bf16 v[200:203], v[68:71], v[28:31], v[200:203]
    v_mfma_f32_16x16x32_bf16 v[204:207], v[72:75], v[28:31], v[204:207]
    v_mfma_f32_16x16x32_bf16 v[208:211], v[60:63], v[32:35], v[208:211]
    ds_read_b128 v[20:23], v1 offset:14336
    v_mfma_f32_16x16x32_bf16 v[212:215], v[64:67], v[32:35], v[212:215]
    v_mfma_f32_16x16x32_bf16 v[216:219], v[68:71], v[32:35], v[216:219]
    v_mfma_f32_16x16x32_bf16 v[220:223], v[72:75], v[32:35], v[220:223]
    v_mfma_f32_16x16x32_bf16 v[224:227], v[60:63], v[36:39], v[224:227]
    ds_read_b128 v[24:27], v1 offset:16384
    v_mfma_f32_16x16x32_bf16 v[228:231], v[64:67], v[36:39], v[228:231]
    v_mfma_f32_16x16x32_bf16 v[232:235], v[68:71], v[36:39], v[232:235]
    v_mfma_f32_16x16x32_bf16 v[236:239], v[72:75], v[36:39], v[236:239]
    s_waitcnt lgkmcnt(8)
    v_mfma_f32_16x16x32_bf16 v[96:99], v[44:47], v[40:43], v[96:99]
    ds_read_b128 v[28:31], v2 offset:0
    v_mfma_f32_16x16x32_bf16 v[100:103], v[48:51], v[40:43], v[100:103]
    v_mfma_f32_16x16x32_bf16 v[104:107], v[52:55], v[40:43], v[104:107]
    v_mfma_f32_16x16x32_bf16 v[108:111], v[56:59], v[40:43], v[108:111]
    s_waitcnt lgkmcnt(8)
    v_mfma_f32_16x16x32_bf16 v[112:115], v[44:47], v[76:79], v[112:115]
    ds_read_b128 v[32:35], v2 offset:2048
    v_mfma_f32_16x16x32_bf16 v[116:119], v[48:51], v[76:79], v[116:119]
    v_mfma_f32_16x16x32_bf16 v[120:123], v[52:55], v[76:79], v[120:123]
    v_mfma_f32_16x16x32_bf16 v[124:127], v[56:59], v[76:79], v[124:127]
    s_waitcnt lgkmcnt(8)
    v_mfma_f32_16x16x32_bf16 v[128:131], v[44:47], v[80:83], v[128:131]
    ds_read_b128 v[36:39], v2 offset:4096
    ds_read_b64_tr_b16 v[60:61], v3 offset:26624
    v_mfma_f32_16x16x32_bf16 v[132:135], v[48:51], v[80:83], v[132:135]
    ds_read_b64_tr_b16 v[62:63], v3 offset:27648
    ds_read_b64_tr_b16 v[64:65], v4 offset:26624
    v_mfma_f32_16x16x32_bf16 v[136:139], v[52:55], v[80:83], v[136:139]
    ds_read_b64_tr_b16 v[66:67], v4 offset:27648
    ds_read_b64_tr_b16 v[68:69], v3 offset:43008
    v_mfma_f32_16x16x32_bf16 v[140:143], v[56:59], v[80:83], v[140:143]
    ds_read_b64_tr_b16 v[70:71], v3 offset:44032
    ds_read_b64_tr_b16 v[72:73], v4 offset:43008
    s_waitcnt lgkmcnt(15)
    v_mfma_f32_16x16x32_bf16 v[144:147], v[44:47], v[84:87], v[144:147]
    ds_read_b64_tr_b16 v[74:75], v4 offset:44032
    v_mfma_f32_16x16x32_bf16 v[148:151], v[48:51], v[84:87], v[148:151]
    ds_read_b128 v[40:43], v2 offset:6144
    v_mfma_f32_16x16x32_bf16 v[152:155], v[52:55], v[84:87], v[152:155]
    v_mfma_f32_16x16x32_bf16 v[156:159], v[56:59], v[84:87], v[156:159]
    s_waitcnt lgkmcnt(15)
    v_mfma_f32_16x16x32_bf16 v[160:163], v[44:47], v[88:91], v[160:163]
    ds_read_b128 v[76:79], v2 offset:8192
    v_mfma_f32_16x16x32_bf16 v[164:167], v[48:51], v[88:91], v[164:167]
    v_mfma_f32_16x16x32_bf16 v[168:171], v[52:55], v[88:91], v[168:171]
    v_mfma_f32_16x16x32_bf16 v[172:175], v[56:59], v[88:91], v[172:175]
    v_mfma_f32_16x16x32_bf16 v[176:179], v[44:47], v[92:95], v[176:179]
    ds_read_b128 v[80:83], v2 offset:10240
    v_mfma_f32_16x16x32_bf16 v[180:183], v[48:51], v[92:95], v[180:183]
    v_mfma_f32_16x16x32_bf16 v[184:187], v[52:55], v[92:95], v[184:187]
    v_mfma_f32_16x16x32_bf16 v[188:191], v[56:59], v[92:95], v[188:191]
    s_waitcnt lgkmcnt(15)
    v_mfma_f32_16x16x32_bf16 v[192:195], v[44:47], v[16:19], v[192:195]
    ds_read_b128 v[84:87], v2 offset:12288
    v_mfma_f32_16x16x32_bf16 v[196:199], v[48:51], v[16:19], v[196:199]
    v_mfma_f32_16x16x32_bf16 v[200:203], v[52:55], v[16:19], v[200:203]
    v_mfma_f32_16x16x32_bf16 v[204:207], v[56:59], v[16:19], v[204:207]
    v_mfma_f32_16x16x32_bf16 v[208:211], v[44:47], v[20:23], v[208:211]
    ds_read_b128 v[88:91], v2 offset:14336
    v_mfma_f32_16x16x32_bf16 v[212:215], v[48:51], v[20:23], v[212:215]
    v_mfma_f32_16x16x32_bf16 v[216:219], v[52:55], v[20:23], v[216:219]
    v_mfma_f32_16x16x32_bf16 v[220:223], v[56:59], v[20:23], v[220:223]
    s_waitcnt lgkmcnt(15)
    v_mfma_f32_16x16x32_bf16 v[224:227], v[44:47], v[24:27], v[224:227]
    ds_read_b128 v[92:95], v2 offset:16384
    v_mfma_f32_16x16x32_bf16 v[228:231], v[48:51], v[24:27], v[228:231]
    v_mfma_f32_16x16x32_bf16 v[232:235], v[52:55], v[24:27], v[232:235]
    v_mfma_f32_16x16x32_bf16 v[236:239], v[56:59], v[24:27], v[236:239]
    s_waitcnt lgkmcnt(6)
    v_mfma_f32_16x16x32_bf16 v[96:99], v[60:63], v[28:31], v[96:99]
    v_mfma_f32_16x16x32_bf16 v[100:103], v[64:67], v[28:31], v[100:103]
    v_mfma_f32_16x16x32_bf16 v[104:107], v[68:71], v[28:31], v[104:107]
    v_mfma_f32_16x16x32_bf16 v[108:111], v[72:75], v[28:31], v[108:111]
    s_waitcnt lgkmcnt(0)
    s_barrier
    v_mfma_f32_16x16x32_bf16 v[112:115], v[60:63], v[32:35], v[112:115]
    ds_read_b64_tr_b16 v[44:45], v7 offset:18432
    ds_read_b64_tr_b16 v[46:47], v7 offset:19456
    v_mfma_f32_16x16x32_bf16 v[116:119], v[64:67], v[32:35], v[116:119]
    ds_read_b64_tr_b16 v[48:49], v8 offset:18432
    ds_read_b64_tr_b16 v[50:51], v8 offset:19456
    v_mfma_f32_16x16x32_bf16 v[120:123], v[68:71], v[32:35], v[120:123]
    ds_read_b64_tr_b16 v[52:53], v7 offset:34816
    ds_read_b64_tr_b16 v[54:55], v7 offset:35840
    v_mfma_f32_16x16x32_bf16 v[124:127], v[72:75], v[32:35], v[124:127]
    ds_read_b64_tr_b16 v[56:57], v8 offset:34816
    ds_read_b64_tr_b16 v[58:59], v8 offset:35840
    v_mfma_f32_16x16x32_bf16 v[128:131], v[60:63], v[36:39], v[128:131]
    ds_read_b128 v[16:19], v5 offset:0
    v_mfma_f32_16x16x32_bf16 v[132:135], v[64:67], v[36:39], v[132:135]
    ds_read_b128 v[20:23], v5 offset:2048
    v_mfma_f32_16x16x32_bf16 v[136:139], v[68:71], v[36:39], v[136:139]
    ds_read_b128 v[24:27], v5 offset:4096
    v_mfma_f32_16x16x32_bf16 v[140:143], v[72:75], v[36:39], v[140:143]
    v_mfma_f32_16x16x32_bf16 v[144:147], v[60:63], v[40:43], v[144:147]
    ds_read_b128 v[28:31], v5 offset:6144
    v_mfma_f32_16x16x32_bf16 v[148:151], v[64:67], v[40:43], v[148:151]
    v_mfma_f32_16x16x32_bf16 v[152:155], v[68:71], v[40:43], v[152:155]
    v_mfma_f32_16x16x32_bf16 v[156:159], v[72:75], v[40:43], v[156:159]
    v_mfma_f32_16x16x32_bf16 v[160:163], v[60:63], v[76:79], v[160:163]
    ds_read_b128 v[32:35], v5 offset:8192
    v_mfma_f32_16x16x32_bf16 v[164:167], v[64:67], v[76:79], v[164:167]
    v_mfma_f32_16x16x32_bf16 v[168:171], v[68:71], v[76:79], v[168:171]
    v_mfma_f32_16x16x32_bf16 v[172:175], v[72:75], v[76:79], v[172:175]
    v_mfma_f32_16x16x32_bf16 v[176:179], v[60:63], v[80:83], v[176:179]
    ds_read_b128 v[36:39], v5 offset:10240
    v_mfma_f32_16x16x32_bf16 v[180:183], v[64:67], v[80:83], v[180:183]
    v_mfma_f32_16x16x32_bf16 v[184:187], v[68:71], v[80:83], v[184:187]
    v_mfma_f32_16x16x32_bf16 v[188:191], v[72:75], v[80:83], v[188:191]
    v_mfma_f32_16x16x32_bf16 v[192:195], v[60:63], v[84:87], v[192:195]
    ds_read_b128 v[40:43], v5 offset:12288
    v_mfma_f32_16x16x32_bf16 v[196:199], v[64:67], v[84:87], v[196:199]
    v_mfma_f32_16x16x32_bf16 v[200:203], v[68:71], v[84:87], v[200:203]
    v_mfma_f32_16x16x32_bf16 v[204:207], v[72:75], v[84:87], v[204:207]
    v_mfma_f32_16x16x32_bf16 v[208:211], v[60:63], v[88:91], v[208:211]
    ds_read_b128 v[76:79], v5 offset:14336
    v_mfma_f32_16x16x32_bf16 v[212:215], v[64:67], v[88:91], v[212:215]
    v_mfma_f32_16x16x32_bf16 v[216:219], v[68:71], v[88:91], v[216:219]
    v_mfma_f32_16x16x32_bf16 v[220:223], v[72:75], v[88:91], v[220:223]
    v_mfma_f32_16x16x32_bf16 v[224:227], v[60:63], v[92:95], v[224:227]
    ds_read_b128 v[80:83], v5 offset:16384
    v_mfma_f32_16x16x32_bf16 v[228:231], v[64:67], v[92:95], v[228:231]
    v_mfma_f32_16x16x32_bf16 v[232:235], v[68:71], v[92:95], v[232:235]
    v_mfma_f32_16x16x32_bf16 v[236:239], v[72:75], v[92:95], v[236:239]
    s_waitcnt lgkmcnt(8)
    v_mfma_f32_16x16x32_bf16 v[96:99], v[44:47], v[16:19], v[96:99]
    ds_read_b128 v[84:87], v6 offset:0
    v_mfma_f32_16x16x32_bf16 v[100:103], v[48:51], v[16:19], v[100:103]
    v_mfma_f32_16x16x32_bf16 v[104:107], v[52:55], v[16:19], v[104:107]
    v_mfma_f32_16x16x32_bf16 v[108:111], v[56:59], v[16:19], v[108:111]
    s_waitcnt lgkmcnt(8)
    v_mfma_f32_16x16x32_bf16 v[112:115], v[44:47], v[20:23], v[112:115]
    ds_read_b128 v[88:91], v6 offset:2048
    v_mfma_f32_16x16x32_bf16 v[116:119], v[48:51], v[20:23], v[116:119]
    v_mfma_f32_16x16x32_bf16 v[120:123], v[52:55], v[20:23], v[120:123]
    v_mfma_f32_16x16x32_bf16 v[124:127], v[56:59], v[20:23], v[124:127]
    s_waitcnt lgkmcnt(8)
    v_mfma_f32_16x16x32_bf16 v[128:131], v[44:47], v[24:27], v[128:131]
    ds_read_b128 v[92:95], v6 offset:4096
    ds_read_b64_tr_b16 v[60:61], v7 offset:26624
    v_mfma_f32_16x16x32_bf16 v[132:135], v[48:51], v[24:27], v[132:135]
    ds_read_b64_tr_b16 v[62:63], v7 offset:27648
    ds_read_b64_tr_b16 v[64:65], v8 offset:26624
    v_mfma_f32_16x16x32_bf16 v[136:139], v[52:55], v[24:27], v[136:139]
    ds_read_b64_tr_b16 v[66:67], v8 offset:27648
    ds_read_b64_tr_b16 v[68:69], v7 offset:43008
    v_mfma_f32_16x16x32_bf16 v[140:143], v[56:59], v[24:27], v[140:143]
    ds_read_b64_tr_b16 v[70:71], v7 offset:44032
    ds_read_b64_tr_b16 v[72:73], v8 offset:43008
    s_waitcnt lgkmcnt(15)
    v_mfma_f32_16x16x32_bf16 v[144:147], v[44:47], v[28:31], v[144:147]
    ds_read_b64_tr_b16 v[74:75], v8 offset:44032
    v_mfma_f32_16x16x32_bf16 v[148:151], v[48:51], v[28:31], v[148:151]
    ds_read_b128 v[16:19], v6 offset:6144
    v_mfma_f32_16x16x32_bf16 v[152:155], v[52:55], v[28:31], v[152:155]
    v_mfma_f32_16x16x32_bf16 v[156:159], v[56:59], v[28:31], v[156:159]
    s_waitcnt lgkmcnt(15)
    v_mfma_f32_16x16x32_bf16 v[160:163], v[44:47], v[32:35], v[160:163]
    ds_read_b128 v[20:23], v6 offset:8192
    v_mfma_f32_16x16x32_bf16 v[164:167], v[48:51], v[32:35], v[164:167]
    v_mfma_f32_16x16x32_bf16 v[168:171], v[52:55], v[32:35], v[168:171]
    v_mfma_f32_16x16x32_bf16 v[172:175], v[56:59], v[32:35], v[172:175]
    v_mfma_f32_16x16x32_bf16 v[176:179], v[44:47], v[36:39], v[176:179]
    ds_read_b128 v[24:27], v6 offset:10240
    v_mfma_f32_16x16x32_bf16 v[180:183], v[48:51], v[36:39], v[180:183]
    v_mfma_f32_16x16x32_bf16 v[184:187], v[52:55], v[36:39], v[184:187]
    v_mfma_f32_16x16x32_bf16 v[188:191], v[56:59], v[36:39], v[188:191]
    s_waitcnt lgkmcnt(15)
    v_mfma_f32_16x16x32_bf16 v[192:195], v[44:47], v[40:43], v[192:195]
    ds_read_b128 v[28:31], v6 offset:12288
    v_mfma_f32_16x16x32_bf16 v[196:199], v[48:51], v[40:43], v[196:199]
    v_mfma_f32_16x16x32_bf16 v[200:203], v[52:55], v[40:43], v[200:203]
    v_mfma_f32_16x16x32_bf16 v[204:207], v[56:59], v[40:43], v[204:207]
    v_mfma_f32_16x16x32_bf16 v[208:211], v[44:47], v[76:79], v[208:211]
    ds_read_b128 v[32:35], v6 offset:14336
    v_mfma_f32_16x16x32_bf16 v[212:215], v[48:51], v[76:79], v[212:215]
    v_mfma_f32_16x16x32_bf16 v[216:219], v[52:55], v[76:79], v[216:219]
    v_mfma_f32_16x16x32_bf16 v[220:223], v[56:59], v[76:79], v[220:223]
    s_waitcnt lgkmcnt(15)
    v_mfma_f32_16x16x32_bf16 v[224:227], v[44:47], v[80:83], v[224:227]
    ds_read_b128 v[36:39], v6 offset:16384
    v_mfma_f32_16x16x32_bf16 v[228:231], v[48:51], v[80:83], v[228:231]
    v_mfma_f32_16x16x32_bf16 v[232:235], v[52:55], v[80:83], v[232:235]
    v_mfma_f32_16x16x32_bf16 v[236:239], v[56:59], v[80:83], v[236:239]
    s_waitcnt lgkmcnt(6)
    v_mfma_f32_16x16x32_bf16 v[96:99], v[60:63], v[84:87], v[96:99]
    v_mfma_f32_16x16x32_bf16 v[100:103], v[64:67], v[84:87], v[100:103]
    v_mfma_f32_16x16x32_bf16 v[104:107], v[68:71], v[84:87], v[104:107]
    v_mfma_f32_16x16x32_bf16 v[108:111], v[72:75], v[84:87], v[108:111]
    s_waitcnt lgkmcnt(0)
    s_barrier
    v_mfma_f32_16x16x32_bf16 v[112:115], v[60:63], v[88:91], v[112:115]
    ds_read_b64_tr_b16 v[44:45], v11 offset:18432
    ds_read_b64_tr_b16 v[46:47], v11 offset:19456
    v_mfma_f32_16x16x32_bf16 v[116:119], v[64:67], v[88:91], v[116:119]
    ds_read_b64_tr_b16 v[48:49], v12 offset:18432
    ds_read_b64_tr_b16 v[50:51], v12 offset:19456
    v_mfma_f32_16x16x32_bf16 v[120:123], v[68:71], v[88:91], v[120:123]
    ds_read_b64_tr_b16 v[52:53], v11 offset:34816
    ds_read_b64_tr_b16 v[54:55], v11 offset:35840
    v_mfma_f32_16x16x32_bf16 v[124:127], v[72:75], v[88:91], v[124:127]
    ds_read_b64_tr_b16 v[56:57], v12 offset:34816
    ds_read_b64_tr_b16 v[58:59], v12 offset:35840
    v_mfma_f32_16x16x32_bf16 v[128:131], v[60:63], v[92:95], v[128:131]
    ds_read_b128 v[40:43], v9 offset:0
    v_mfma_f32_16x16x32_bf16 v[132:135], v[64:67], v[92:95], v[132:135]
    ds_read_b128 v[76:79], v9 offset:2048
    v_mfma_f32_16x16x32_bf16 v[136:139], v[68:71], v[92:95], v[136:139]
    ds_read_b128 v[80:83], v9 offset:4096
    v_mfma_f32_16x16x32_bf16 v[140:143], v[72:75], v[92:95], v[140:143]
    v_mfma_f32_16x16x32_bf16 v[144:147], v[60:63], v[16:19], v[144:147]
    ds_read_b128 v[84:87], v9 offset:6144
    v_mfma_f32_16x16x32_bf16 v[148:151], v[64:67], v[16:19], v[148:151]
    v_mfma_f32_16x16x32_bf16 v[152:155], v[68:71], v[16:19], v[152:155]
    v_mfma_f32_16x16x32_bf16 v[156:159], v[72:75], v[16:19], v[156:159]
    v_mfma_f32_16x16x32_bf16 v[160:163], v[60:63], v[20:23], v[160:163]
    ds_read_b128 v[88:91], v9 offset:8192
    v_mfma_f32_16x16x32_bf16 v[164:167], v[64:67], v[20:23], v[164:167]
    v_mfma_f32_16x16x32_bf16 v[168:171], v[68:71], v[20:23], v[168:171]
    v_mfma_f32_16x16x32_bf16 v[172:175], v[72:75], v[20:23], v[172:175]
    v_mfma_f32_16x16x32_bf16 v[176:179], v[60:63], v[24:27], v[176:179]
    ds_read_b128 v[92:95], v9 offset:10240
    v_mfma_f32_16x16x32_bf16 v[180:183], v[64:67], v[24:27], v[180:183]
    v_mfma_f32_16x16x32_bf16 v[184:187], v[68:71], v[24:27], v[184:187]
    v_mfma_f32_16x16x32_bf16 v[188:191], v[72:75], v[24:27], v[188:191]
    v_mfma_f32_16x16x32_bf16 v[192:195], v[60:63], v[28:31], v[192:195]
    ds_read_b128 v[16:19], v9 offset:12288
    v_mfma_f32_16x16x32_bf16 v[196:199], v[64:67], v[28:31], v[196:199]
    v_mfma_f32_16x16x32_bf16 v[200:203], v[68:71], v[28:31], v[200:203]
    v_mfma_f32_16x16x32_bf16 v[204:207], v[72:75], v[28:31], v[204:207]
    v_mfma_f32_16x16x32_bf16 v[208:211], v[60:63], v[32:35], v[208:211]
    ds_read_b128 v[20:23], v9 offset:14336
    v_mfma_f32_16x16x32_bf16 v[212:215], v[64:67], v[32:35], v[212:215]
    v_mfma_f32_16x16x32_bf16 v[216:219], v[68:71], v[32:35], v[216:219]
    v_mfma_f32_16x16x32_bf16 v[220:223], v[72:75], v[32:35], v[220:223]
    v_mfma_f32_16x16x32_bf16 v[224:227], v[60:63], v[36:39], v[224:227]
    ds_read_b128 v[24:27], v9 offset:16384
    v_mfma_f32_16x16x32_bf16 v[228:231], v[64:67], v[36:39], v[228:231]
    v_mfma_f32_16x16x32_bf16 v[232:235], v[68:71], v[36:39], v[232:235]
    v_mfma_f32_16x16x32_bf16 v[236:239], v[72:75], v[36:39], v[236:239]
    s_waitcnt lgkmcnt(8)
    v_mfma_f32_16x16x32_bf16 v[96:99], v[44:47], v[40:43], v[96:99]
    ds_read_b128 v[28:31], v10 offset:0
    v_mfma_f32_16x16x32_bf16 v[100:103], v[48:51], v[40:43], v[100:103]
    v_mfma_f32_16x16x32_bf16 v[104:107], v[52:55], v[40:43], v[104:107]
    v_mfma_f32_16x16x32_bf16 v[108:111], v[56:59], v[40:43], v[108:111]
    s_waitcnt lgkmcnt(8)
    v_mfma_f32_16x16x32_bf16 v[112:115], v[44:47], v[76:79], v[112:115]
    ds_read_b128 v[32:35], v10 offset:2048
    v_mfma_f32_16x16x32_bf16 v[116:119], v[48:51], v[76:79], v[116:119]
    v_mfma_f32_16x16x32_bf16 v[120:123], v[52:55], v[76:79], v[120:123]
    v_mfma_f32_16x16x32_bf16 v[124:127], v[56:59], v[76:79], v[124:127]
    s_waitcnt lgkmcnt(8)
    v_mfma_f32_16x16x32_bf16 v[128:131], v[44:47], v[80:83], v[128:131]
    ds_read_b128 v[36:39], v10 offset:4096
    ds_read_b64_tr_b16 v[60:61], v11 offset:26624
    v_mfma_f32_16x16x32_bf16 v[132:135], v[48:51], v[80:83], v[132:135]
    ds_read_b64_tr_b16 v[62:63], v11 offset:27648
    ds_read_b64_tr_b16 v[64:65], v12 offset:26624
    v_mfma_f32_16x16x32_bf16 v[136:139], v[52:55], v[80:83], v[136:139]
    ds_read_b64_tr_b16 v[66:67], v12 offset:27648
    ds_read_b64_tr_b16 v[68:69], v11 offset:43008
    v_mfma_f32_16x16x32_bf16 v[140:143], v[56:59], v[80:83], v[140:143]
    ds_read_b64_tr_b16 v[70:71], v11 offset:44032
    ds_read_b64_tr_b16 v[72:73], v12 offset:43008
    s_waitcnt lgkmcnt(15)
    v_mfma_f32_16x16x32_bf16 v[144:147], v[44:47], v[84:87], v[144:147]
    ds_read_b64_tr_b16 v[74:75], v12 offset:44032
    v_mfma_f32_16x16x32_bf16 v[148:151], v[48:51], v[84:87], v[148:151]
    ds_read_b128 v[40:43], v10 offset:6144
    v_mfma_f32_16x16x32_bf16 v[152:155], v[52:55], v[84:87], v[152:155]
    v_mfma_f32_16x16x32_bf16 v[156:159], v[56:59], v[84:87], v[156:159]
    s_waitcnt lgkmcnt(15)
    v_mfma_f32_16x16x32_bf16 v[160:163], v[44:47], v[88:91], v[160:163]
    ds_read_b128 v[76:79], v10 offset:8192
    v_mfma_f32_16x16x32_bf16 v[164:167], v[48:51], v[88:91], v[164:167]
    v_mfma_f32_16x16x32_bf16 v[168:171], v[52:55], v[88:91], v[168:171]
    v_mfma_f32_16x16x32_bf16 v[172:175], v[56:59], v[88:91], v[172:175]
    v_mfma_f32_16x16x32_bf16 v[176:179], v[44:47], v[92:95], v[176:179]
    ds_read_b128 v[80:83], v10 offset:10240
    v_mfma_f32_16x16x32_bf16 v[180:183], v[48:51], v[92:95], v[180:183]
    v_mfma_f32_16x16x32_bf16 v[184:187], v[52:55], v[92:95], v[184:187]
    v_mfma_f32_16x16x32_bf16 v[188:191], v[56:59], v[92:95], v[188:191]
    s_waitcnt lgkmcnt(15)
    v_mfma_f32_16x16x32_bf16 v[192:195], v[44:47], v[16:19], v[192:195]
    ds_read_b128 v[84:87], v10 offset:12288
    v_mfma_f32_16x16x32_bf16 v[196:199], v[48:51], v[16:19], v[196:199]
    v_mfma_f32_16x16x32_bf16 v[200:203], v[52:55], v[16:19], v[200:203]
    v_mfma_f32_16x16x32_bf16 v[204:207], v[56:59], v[16:19], v[204:207]
    v_mfma_f32_16x16x32_bf16 v[208:211], v[44:47], v[20:23], v[208:211]
    ds_read_b128 v[88:91], v10 offset:14336
    v_mfma_f32_16x16x32_bf16 v[212:215], v[48:51], v[20:23], v[212:215]
    v_mfma_f32_16x16x32_bf16 v[216:219], v[52:55], v[20:23], v[216:219]
    v_mfma_f32_16x16x32_bf16 v[220:223], v[56:59], v[20:23], v[220:223]
    s_waitcnt lgkmcnt(15)
    v_mfma_f32_16x16x32_bf16 v[224:227], v[44:47], v[24:27], v[224:227]
    ds_read_b128 v[92:95], v10 offset:16384
    v_mfma_f32_16x16x32_bf16 v[228:231], v[48:51], v[24:27], v[228:231]
    v_mfma_f32_16x16x32_bf16 v[232:235], v[52:55], v[24:27], v[232:235]
    v_mfma_f32_16x16x32_bf16 v[236:239], v[56:59], v[24:27], v[236:239]
    s_waitcnt lgkmcnt(6)
    v_mfma_f32_16x16x32_bf16 v[96:99], v[60:63], v[28:31], v[96:99]
    v_mfma_f32_16x16x32_bf16 v[100:103], v[64:67], v[28:31], v[100:103]
    v_mfma_f32_16x16x32_bf16 v[104:107], v[68:71], v[28:31], v[104:107]
    v_mfma_f32_16x16x32_bf16 v[108:111], v[72:75], v[28:31], v[108:111]
    s_waitcnt lgkmcnt(0)
    s_barrier
    v_mfma_f32_16x16x32_bf16 v[112:115], v[60:63], v[32:35], v[112:115]
    ds_read_b64_tr_b16 v[44:45], v3 offset:18432
    ds_read_b64_tr_b16 v[46:47], v3 offset:19456
    v_mfma_f32_16x16x32_bf16 v[116:119], v[64:67], v[32:35], v[116:119]
    ds_read_b64_tr_b16 v[48:49], v4 offset:18432
    ds_read_b64_tr_b16 v[50:51], v4 offset:19456
    v_mfma_f32_16x16x32_bf16 v[120:123], v[68:71], v[32:35], v[120:123]
    ds_read_b64_tr_b16 v[52:53], v3 offset:34816
    ds_read_b64_tr_b16 v[54:55], v3 offset:35840
    v_mfma_f32_16x16x32_bf16 v[124:127], v[72:75], v[32:35], v[124:127]
    ds_read_b64_tr_b16 v[56:57], v4 offset:34816
    ds_read_b64_tr_b16 v[58:59], v4 offset:35840
    v_mfma_f32_16x16x32_bf16 v[128:131], v[60:63], v[36:39], v[128:131]
    ds_read_b128 v[16:19], v1 offset:0
    v_mfma_f32_16x16x32_bf16 v[132:135], v[64:67], v[36:39], v[132:135]
    ds_read_b128 v[20:23], v1 offset:2048
    v_mfma_f32_16x16x32_bf16 v[136:139], v[68:71], v[36:39], v[136:139]
    ds_read_b128 v[24:27], v1 offset:4096
    v_mfma_f32_16x16x32_bf16 v[140:143], v[72:75], v[36:39], v[140:143]
    v_mfma_f32_16x16x32_bf16 v[144:147], v[60:63], v[40:43], v[144:147]
    ds_read_b128 v[28:31], v1 offset:6144
    v_mfma_f32_16x16x32_bf16 v[148:151], v[64:67], v[40:43], v[148:151]
    v_mfma_f32_16x16x32_bf16 v[152:155], v[68:71], v[40:43], v[152:155]
    v_mfma_f32_16x16x32_bf16 v[156:159], v[72:75], v[40:43], v[156:159]
    v_mfma_f32_16x16x32_bf16 v[160:163], v[60:63], v[76:79], v[160:163]
    ds_read_b128 v[32:35], v1 offset:8192
    v_mfma_f32_16x16x32_bf16 v[164:167], v[64:67], v[76:79], v[164:167]
    v_mfma_f32_16x16x32_bf16 v[168:171], v[68:71], v[76:79], v[168:171]
    v_mfma_f32_16x16x32_bf16 v[172:175], v[72:75], v[76:79], v[172:175]
    v_mfma_f32_16x16x32_bf16 v[176:179], v[60:63], v[80:83], v[176:179]
    ds_read_b128 v[36:39], v1 offset:10240
    v_mfma_f32_16x16x32_bf16 v[180:183], v[64:67], v[80:83], v[180:183]
    v_mfma_f32_16x16x32_bf16 v[184:187], v[68:71], v[80:83], v[184:187]
    v_mfma_f32_16x16x32_bf16 v[188:191], v[72:75], v[80:83], v[188:191]
    v_mfma_f32_16x16x32_bf16 v[192:195], v[60:63], v[84:87], v[192:195]
    ds_read_b128 v[40:43], v1 offset:12288
    v_mfma_f32_16x16x32_bf16 v[196:199], v[64:67], v[84:87], v[196:199]
    v_mfma_f32_16x16x32_bf16 v[200:203], v[68:71], v[84:87], v[200:203]
    v_mfma_f32_16x16x32_bf16 v[204:207], v[72:75], v[84:87], v[204:207]
    v_mfma_f32_16x16x32_bf16 v[208:211], v[60:63], v[88:91], v[208:211]
    ds_read_b128 v[76:79], v1 offset:14336
    v_mfma_f32_16x16x32_bf16 v[212:215], v[64:67], v[88:91], v[212:215]
    v_mfma_f32_16x16x32_bf16 v[216:219], v[68:71], v[88:91], v[216:219]
    v_mfma_f32_16x16x32_bf16 v[220:223], v[72:75], v[88:91], v[220:223]
    v_mfma_f32_16x16x32_bf16 v[224:227], v[60:63], v[92:95], v[224:227]
    ds_read_b128 v[80:83], v1 offset:16384
    v_mfma_f32_16x16x32_bf16 v[228:231], v[64:67], v[92:95], v[228:231]
    v_mfma_f32_16x16x32_bf16 v[232:235], v[68:71], v[92:95], v[232:235]
    v_mfma_f32_16x16x32_bf16 v[236:239], v[72:75], v[92:95], v[236:239]
    s_waitcnt lgkmcnt(8)
    v_mfma_f32_16x16x32_bf16 v[96:99], v[44:47], v[16:19], v[96:99]
    ds_read_b128 v[84:87], v2 offset:0
    v_mfma_f32_16x16x32_bf16 v[100:103], v[48:51], v[16:19], v[100:103]
    v_mfma_f32_16x16x32_bf16 v[104:107], v[52:55], v[16:19], v[104:107]
    v_mfma_f32_16x16x32_bf16 v[108:111], v[56:59], v[16:19], v[108:111]
    s_waitcnt lgkmcnt(8)
    v_mfma_f32_16x16x32_bf16 v[112:115], v[44:47], v[20:23], v[112:115]
    ds_read_b128 v[88:91], v2 offset:2048
    v_mfma_f32_16x16x32_bf16 v[116:119], v[48:51], v[20:23], v[116:119]
    v_mfma_f32_16x16x32_bf16 v[120:123], v[52:55], v[20:23], v[120:123]
    v_mfma_f32_16x16x32_bf16 v[124:127], v[56:59], v[20:23], v[124:127]
    s_waitcnt lgkmcnt(8)
    v_mfma_f32_16x16x32_bf16 v[128:131], v[44:47], v[24:27], v[128:131]
    ds_read_b128 v[92:95], v2 offset:4096
    ds_read_b64_tr_b16 v[60:61], v3 offset:26624
    v_mfma_f32_16x16x32_bf16 v[132:135], v[48:51], v[24:27], v[132:135]
    ds_read_b64_tr_b16 v[62:63], v3 offset:27648
    ds_read_b64_tr_b16 v[64:65], v4 offset:26624
    v_mfma_f32_16x16x32_bf16 v[136:139], v[52:55], v[24:27], v[136:139]
    ds_read_b64_tr_b16 v[66:67], v4 offset:27648
    ds_read_b64_tr_b16 v[68:69], v3 offset:43008
    v_mfma_f32_16x16x32_bf16 v[140:143], v[56:59], v[24:27], v[140:143]
    ds_read_b64_tr_b16 v[70:71], v3 offset:44032
    ds_read_b64_tr_b16 v[72:73], v4 offset:43008
    s_waitcnt lgkmcnt(15)
    v_mfma_f32_16x16x32_bf16 v[144:147], v[44:47], v[28:31], v[144:147]
    ds_read_b64_tr_b16 v[74:75], v4 offset:44032
    v_mfma_f32_16x16x32_bf16 v[148:151], v[48:51], v[28:31], v[148:151]
    ds_read_b128 v[16:19], v2 offset:6144
    v_mfma_f32_16x16x32_bf16 v[152:155], v[52:55], v[28:31], v[152:155]
    v_mfma_f32_16x16x32_bf16 v[156:159], v[56:59], v[28:31], v[156:159]
    s_waitcnt lgkmcnt(15)
    v_mfma_f32_16x16x32_bf16 v[160:163], v[44:47], v[32:35], v[160:163]
    ds_read_b128 v[20:23], v2 offset:8192
    v_mfma_f32_16x16x32_bf16 v[164:167], v[48:51], v[32:35], v[164:167]
    v_mfma_f32_16x16x32_bf16 v[168:171], v[52:55], v[32:35], v[168:171]
    v_mfma_f32_16x16x32_bf16 v[172:175], v[56:59], v[32:35], v[172:175]
    v_mfma_f32_16x16x32_bf16 v[176:179], v[44:47], v[36:39], v[176:179]
    ds_read_b128 v[24:27], v2 offset:10240
    v_mfma_f32_16x16x32_bf16 v[180:183], v[48:51], v[36:39], v[180:183]
    v_mfma_f32_16x16x32_bf16 v[184:187], v[52:55], v[36:39], v[184:187]
    v_mfma_f32_16x16x32_bf16 v[188:191], v[56:59], v[36:39], v[188:191]
    s_waitcnt lgkmcnt(15)
    v_mfma_f32_16x16x32_bf16 v[192:195], v[44:47], v[40:43], v[192:195]
    ds_read_b128 v[28:31], v2 offset:12288
    v_mfma_f32_16x16x32_bf16 v[196:199], v[48:51], v[40:43], v[196:199]
    v_mfma_f32_16x16x32_bf16 v[200:203], v[52:55], v[40:43], v[200:203]
    v_mfma_f32_16x16x32_bf16 v[204:207], v[56:59], v[40:43], v[204:207]
    v_mfma_f32_16x16x32_bf16 v[208:211], v[44:47], v[76:79], v[208:211]
    ds_read_b128 v[32:35], v2 offset:14336
    v_mfma_f32_16x16x32_bf16 v[212:215], v[48:51], v[76:79], v[212:215]
    v_mfma_f32_16x16x32_bf16 v[216:219], v[52:55], v[76:79], v[216:219]
    v_mfma_f32_16x16x32_bf16 v[220:223], v[56:59], v[76:79], v[220:223]
    s_waitcnt lgkmcnt(15)
    v_mfma_f32_16x16x32_bf16 v[224:227], v[44:47], v[80:83], v[224:227]
    ds_read_b128 v[36:39], v2 offset:16384
    v_mfma_f32_16x16x32_bf16 v[228:231], v[48:51], v[80:83], v[228:231]
    v_mfma_f32_16x16x32_bf16 v[232:235], v[52:55], v[80:83], v[232:235]
    v_mfma_f32_16x16x32_bf16 v[236:239], v[56:59], v[80:83], v[236:239]
    s_waitcnt lgkmcnt(6)
    v_mfma_f32_16x16x32_bf16 v[96:99], v[60:63], v[84:87], v[96:99]
    v_mfma_f32_16x16x32_bf16 v[100:103], v[64:67], v[84:87], v[100:103]
    v_mfma_f32_16x16x32_bf16 v[104:107], v[68:71], v[84:87], v[104:107]
    v_mfma_f32_16x16x32_bf16 v[108:111], v[72:75], v[84:87], v[108:111]
    s_waitcnt lgkmcnt(0)
    s_barrier
    v_mfma_f32_16x16x32_bf16 v[112:115], v[60:63], v[88:91], v[112:115]
    ds_read_b64_tr_b16 v[44:45], v7 offset:18432
    ds_read_b64_tr_b16 v[46:47], v7 offset:19456
    v_mfma_f32_16x16x32_bf16 v[116:119], v[64:67], v[88:91], v[116:119]
    ds_read_b64_tr_b16 v[48:49], v8 offset:18432
    ds_read_b64_tr_b16 v[50:51], v8 offset:19456
    v_mfma_f32_16x16x32_bf16 v[120:123], v[68:71], v[88:91], v[120:123]
    ds_read_b64_tr_b16 v[52:53], v7 offset:34816
    ds_read_b64_tr_b16 v[54:55], v7 offset:35840
    v_mfma_f32_16x16x32_bf16 v[124:127], v[72:75], v[88:91], v[124:127]
    ds_read_b64_tr_b16 v[56:57], v8 offset:34816
    ds_read_b64_tr_b16 v[58:59], v8 offset:35840
    v_mfma_f32_16x16x32_bf16 v[128:131], v[60:63], v[92:95], v[128:131]
    ds_read_b128 v[40:43], v5 offset:0
    v_mfma_f32_16x16x32_bf16 v[132:135], v[64:67], v[92:95], v[132:135]
    ds_read_b128 v[76:79], v5 offset:2048
    v_mfma_f32_16x16x32_bf16 v[136:139], v[68:71], v[92:95], v[136:139]
    ds_read_b128 v[80:83], v5 offset:4096
    v_mfma_f32_16x16x32_bf16 v[140:143], v[72:75], v[92:95], v[140:143]
    v_mfma_f32_16x16x32_bf16 v[144:147], v[60:63], v[16:19], v[144:147]
    ds_read_b128 v[84:87], v5 offset:6144
    v_mfma_f32_16x16x32_bf16 v[148:151], v[64:67], v[16:19], v[148:151]
    v_mfma_f32_16x16x32_bf16 v[152:155], v[68:71], v[16:19], v[152:155]
    v_mfma_f32_16x16x32_bf16 v[156:159], v[72:75], v[16:19], v[156:159]
    v_mfma_f32_16x16x32_bf16 v[160:163], v[60:63], v[20:23], v[160:163]
    ds_read_b128 v[88:91], v5 offset:8192
    v_mfma_f32_16x16x32_bf16 v[164:167], v[64:67], v[20:23], v[164:167]
    v_mfma_f32_16x16x32_bf16 v[168:171], v[68:71], v[20:23], v[168:171]
    v_mfma_f32_16x16x32_bf16 v[172:175], v[72:75], v[20:23], v[172:175]
    v_mfma_f32_16x16x32_bf16 v[176:179], v[60:63], v[24:27], v[176:179]
    ds_read_b128 v[92:95], v5 offset:10240
    v_mfma_f32_16x16x32_bf16 v[180:183], v[64:67], v[24:27], v[180:183]
    v_mfma_f32_16x16x32_bf16 v[184:187], v[68:71], v[24:27], v[184:187]
    v_mfma_f32_16x16x32_bf16 v[188:191], v[72:75], v[24:27], v[188:191]
    v_mfma_f32_16x16x32_bf16 v[192:195], v[60:63], v[28:31], v[192:195]
    ds_read_b128 v[16:19], v5 offset:12288
    v_mfma_f32_16x16x32_bf16 v[196:199], v[64:67], v[28:31], v[196:199]
    v_mfma_f32_16x16x32_bf16 v[200:203], v[68:71], v[28:31], v[200:203]
    v_mfma_f32_16x16x32_bf16 v[204:207], v[72:75], v[28:31], v[204:207]
    v_mfma_f32_16x16x32_bf16 v[208:211], v[60:63], v[32:35], v[208:211]
    ds_read_b128 v[20:23], v5 offset:14336
    v_mfma_f32_16x16x32_bf16 v[212:215], v[64:67], v[32:35], v[212:215]
    v_mfma_f32_16x16x32_bf16 v[216:219], v[68:71], v[32:35], v[216:219]
    v_mfma_f32_16x16x32_bf16 v[220:223], v[72:75], v[32:35], v[220:223]
    v_mfma_f32_16x16x32_bf16 v[224:227], v[60:63], v[36:39], v[224:227]
    ds_read_b128 v[24:27], v5 offset:16384
    v_mfma_f32_16x16x32_bf16 v[228:231], v[64:67], v[36:39], v[228:231]
    v_mfma_f32_16x16x32_bf16 v[232:235], v[68:71], v[36:39], v[232:235]
    v_mfma_f32_16x16x32_bf16 v[236:239], v[72:75], v[36:39], v[236:239]
    s_waitcnt lgkmcnt(8)
    v_mfma_f32_16x16x32_bf16 v[96:99], v[44:47], v[40:43], v[96:99]
    ds_read_b128 v[28:31], v6 offset:0
    v_mfma_f32_16x16x32_bf16 v[100:103], v[48:51], v[40:43], v[100:103]
    v_mfma_f32_16x16x32_bf16 v[104:107], v[52:55], v[40:43], v[104:107]
    v_mfma_f32_16x16x32_bf16 v[108:111], v[56:59], v[40:43], v[108:111]
    s_waitcnt lgkmcnt(8)
    v_mfma_f32_16x16x32_bf16 v[112:115], v[44:47], v[76:79], v[112:115]
    ds_read_b128 v[32:35], v6 offset:2048
    v_mfma_f32_16x16x32_bf16 v[116:119], v[48:51], v[76:79], v[116:119]
    v_mfma_f32_16x16x32_bf16 v[120:123], v[52:55], v[76:79], v[120:123]
    v_mfma_f32_16x16x32_bf16 v[124:127], v[56:59], v[76:79], v[124:127]
    s_waitcnt lgkmcnt(8)
    v_mfma_f32_16x16x32_bf16 v[128:131], v[44:47], v[80:83], v[128:131]
    ds_read_b128 v[36:39], v6 offset:4096
    ds_read_b64_tr_b16 v[60:61], v7 offset:26624
    v_mfma_f32_16x16x32_bf16 v[132:135], v[48:51], v[80:83], v[132:135]
    ds_read_b64_tr_b16 v[62:63], v7 offset:27648
    ds_read_b64_tr_b16 v[64:65], v8 offset:26624
    v_mfma_f32_16x16x32_bf16 v[136:139], v[52:55], v[80:83], v[136:139]
    ds_read_b64_tr_b16 v[66:67], v8 offset:27648
    ds_read_b64_tr_b16 v[68:69], v7 offset:43008
    v_mfma_f32_16x16x32_bf16 v[140:143], v[56:59], v[80:83], v[140:143]
    ds_read_b64_tr_b16 v[70:71], v7 offset:44032
    ds_read_b64_tr_b16 v[72:73], v8 offset:43008
    s_waitcnt lgkmcnt(15)
    v_mfma_f32_16x16x32_bf16 v[144:147], v[44:47], v[84:87], v[144:147]
    ds_read_b64_tr_b16 v[74:75], v8 offset:44032
    v_mfma_f32_16x16x32_bf16 v[148:151], v[48:51], v[84:87], v[148:151]
    ds_read_b128 v[40:43], v6 offset:6144
    v_mfma_f32_16x16x32_bf16 v[152:155], v[52:55], v[84:87], v[152:155]
    v_mfma_f32_16x16x32_bf16 v[156:159], v[56:59], v[84:87], v[156:159]
    s_waitcnt lgkmcnt(15)
    v_mfma_f32_16x16x32_bf16 v[160:163], v[44:47], v[88:91], v[160:163]
    ds_read_b128 v[76:79], v6 offset:8192
    v_mfma_f32_16x16x32_bf16 v[164:167], v[48:51], v[88:91], v[164:167]
    v_mfma_f32_16x16x32_bf16 v[168:171], v[52:55], v[88:91], v[168:171]
    v_mfma_f32_16x16x32_bf16 v[172:175], v[56:59], v[88:91], v[172:175]
    v_mfma_f32_16x16x32_bf16 v[176:179], v[44:47], v[92:95], v[176:179]
    ds_read_b128 v[80:83], v6 offset:10240
    v_mfma_f32_16x16x32_bf16 v[180:183], v[48:51], v[92:95], v[180:183]
    v_mfma_f32_16x16x32_bf16 v[184:187], v[52:55], v[92:95], v[184:187]
    v_mfma_f32_16x16x32_bf16 v[188:191], v[56:59], v[92:95], v[188:191]
    s_waitcnt lgkmcnt(15)
    v_mfma_f32_16x16x32_bf16 v[192:195], v[44:47], v[16:19], v[192:195]
    ds_read_b128 v[84:87], v6 offset:12288
    v_mfma_f32_16x16x32_bf16 v[196:199], v[48:51], v[16:19], v[196:199]
    v_mfma_f32_16x16x32_bf16 v[200:203], v[52:55], v[16:19], v[200:203]
    v_mfma_f32_16x16x32_bf16 v[204:207], v[56:59], v[16:19], v[204:207]
    v_mfma_f32_16x16x32_bf16 v[208:211], v[44:47], v[20:23], v[208:211]
    ds_read_b128 v[88:91], v6 offset:14336
    v_mfma_f32_16x16x32_bf16 v[212:215], v[48:51], v[20:23], v[212:215]
    v_mfma_f32_16x16x32_bf16 v[216:219], v[52:55], v[20:23], v[216:219]
    v_mfma_f32_16x16x32_bf16 v[220:223], v[56:59], v[20:23], v[220:223]
    s_waitcnt lgkmcnt(15)
    v_mfma_f32_16x16x32_bf16 v[224:227], v[44:47], v[24:27], v[224:227]
    ds_read_b128 v[92:95], v6 offset:16384
    v_mfma_f32_16x16x32_bf16 v[228:231], v[48:51], v[24:27], v[228:231]
    v_mfma_f32_16x16x32_bf16 v[232:235], v[52:55], v[24:27], v[232:235]
    v_mfma_f32_16x16x32_bf16 v[236:239], v[56:59], v[24:27], v[236:239]
    s_waitcnt lgkmcnt(6)
    v_mfma_f32_16x16x32_bf16 v[96:99], v[60:63], v[28:31], v[96:99]
    v_mfma_f32_16x16x32_bf16 v[100:103], v[64:67], v[28:31], v[100:103]
    v_mfma_f32_16x16x32_bf16 v[104:107], v[68:71], v[28:31], v[104:107]
    v_mfma_f32_16x16x32_bf16 v[108:111], v[72:75], v[28:31], v[108:111]
    v_mfma_f32_16x16x32_bf16 v[112:115], v[60:63], v[32:35], v[112:115]
    v_mfma_f32_16x16x32_bf16 v[116:119], v[64:67], v[32:35], v[116:119]
    v_mfma_f32_16x16x32_bf16 v[120:123], v[68:71], v[32:35], v[120:123]
    v_mfma_f32_16x16x32_bf16 v[124:127], v[72:75], v[32:35], v[124:127]
    v_mfma_f32_16x16x32_bf16 v[128:131], v[60:63], v[36:39], v[128:131]
    v_mfma_f32_16x16x32_bf16 v[132:135], v[64:67], v[36:39], v[132:135]
    v_mfma_f32_16x16x32_bf16 v[136:139], v[68:71], v[36:39], v[136:139]
    v_mfma_f32_16x16x32_bf16 v[140:143], v[72:75], v[36:39], v[140:143]
    s_waitcnt lgkmcnt(5)
    v_mfma_f32_16x16x32_bf16 v[144:147], v[60:63], v[40:43], v[144:147]
    v_mfma_f32_16x16x32_bf16 v[148:151], v[64:67], v[40:43], v[148:151]
    v_mfma_f32_16x16x32_bf16 v[152:155], v[68:71], v[40:43], v[152:155]
    v_mfma_f32_16x16x32_bf16 v[156:159], v[72:75], v[40:43], v[156:159]
    s_waitcnt lgkmcnt(4)
    v_mfma_f32_16x16x32_bf16 v[160:163], v[60:63], v[76:79], v[160:163]
    v_mfma_f32_16x16x32_bf16 v[164:167], v[64:67], v[76:79], v[164:167]
    v_mfma_f32_16x16x32_bf16 v[168:171], v[68:71], v[76:79], v[168:171]
    v_mfma_f32_16x16x32_bf16 v[172:175], v[72:75], v[76:79], v[172:175]
    s_waitcnt lgkmcnt(3)
    v_mfma_f32_16x16x32_bf16 v[176:179], v[60:63], v[80:83], v[176:179]
    v_mfma_f32_16x16x32_bf16 v[180:183], v[64:67], v[80:83], v[180:183]
    v_mfma_f32_16x16x32_bf16 v[184:187], v[68:71], v[80:83], v[184:187]
    v_mfma_f32_16x16x32_bf16 v[188:191], v[72:75], v[80:83], v[188:191]
    s_waitcnt lgkmcnt(2)
    v_mfma_f32_16x16x32_bf16 v[192:195], v[60:63], v[84:87], v[192:195]
    v_mfma_f32_16x16x32_bf16 v[196:199], v[64:67], v[84:87], v[196:199]
    v_mfma_f32_16x16x32_bf16 v[200:203], v[68:71], v[84:87], v[200:203]
    v_mfma_f32_16x16x32_bf16 v[204:207], v[72:75], v[84:87], v[204:207]
    s_waitcnt lgkmcnt(1)
    v_mfma_f32_16x16x32_bf16 v[208:211], v[60:63], v[88:91], v[208:211]
    v_mfma_f32_16x16x32_bf16 v[212:215], v[64:67], v[88:91], v[212:215]
    v_mfma_f32_16x16x32_bf16 v[216:219], v[68:71], v[88:91], v[216:219]
    v_mfma_f32_16x16x32_bf16 v[220:223], v[72:75], v[88:91], v[220:223]
    s_waitcnt lgkmcnt(0)
    v_mfma_f32_16x16x32_bf16 v[224:227], v[60:63], v[92:95], v[224:227]
    v_mfma_f32_16x16x32_bf16 v[228:231], v[64:67], v[92:95], v[228:231]
    v_mfma_f32_16x16x32_bf16 v[232:235], v[68:71], v[92:95], v[232:235]
    v_mfma_f32_16x16x32_bf16 v[236:239], v[72:75], v[92:95], v[236:239]
    s_mov_b32 s56, -1
    s_cmp_eq_u32 s44, 14
    s_cselect_b32 s56, 0x3fff3fff, s56
    s_mov_b32 s57, s56
    s_mov_b32 s58, 0x7fff7fff
    s_mov_b32 s59, s58
    s_mul_i32 s3, s44, 143
    v_add_u32 v1, s3, v13
    v_lshrrev_b32 v2, 1, v14
    v_lshlrev_b32 v2, 9, v2
    v_and_b32 v3, 1, v14
    v_lshl_add_u32 v2, v3, 3, v2
    s_mov_b32 s3, 88064
    v_add_u32 v3, 0, v1
    v_lshrrev_b32 v4, 5, v3
    v_and_b32 v3, 31, v3
    v_lshl_add_u32 v3, v3, 4, v2
    v_mad_u32_u24 v84, v4, s3, v3
    v_add_u32 v3, 16, v1
    v_lshrrev_b32 v4, 5, v3
    v_and_b32 v3, 31, v3
    v_lshl_add_u32 v3, v3, 4, v2
    v_mad_u32_u24 v85, v4, s3, v3
    v_add_u32 v3, 32, v1
    v_lshrrev_b32 v4, 5, v3
    v_and_b32 v3, 31, v3
    v_lshl_add_u32 v3, v3, 4, v2
    v_mad_u32_u24 v86, v4, s3, v3
    v_add_u32 v3, 48, v1
    v_lshrrev_b32 v4, 5, v3
    v_and_b32 v3, 31, v3
    v_lshl_add_u32 v3, v3, 4, v2
    v_mad_u32_u24 v87, v4, s3, v3
    v_add_u32 v3, 64, v1
    v_lshrrev_b32 v4, 5, v3
    v_and_b32 v3, 31, v3
    v_lshl_add_u32 v3, v3, 4, v2
    v_mad_u32_u24 v88, v4, s3, v3
    v_add_u32 v3, 80, v1
    v_lshrrev_b32 v4, 5, v3
    v_and_b32 v3, 31, v3
    v_lshl_add_u32 v3, v3, 4, v2
    v_mad_u32_u24 v89, v4, s3, v3
    v_add_u32 v3, 96, v1
    v_lshrrev_b32 v4, 5, v3
    v_and_b32 v3, 31, v3
    v_lshl_add_u32 v3, v3, 4, v2
    v_mad_u32_u24 v90, v4, s3, v3
    v_add_u32 v3, 112, v1
    v_lshrrev_b32 v4, 5, v3
    v_and_b32 v3, 31, v3
    v_lshl_add_u32 v3, v3, 4, v2
    v_mad_u32_u24 v91, v4, s3, v3
    v_add_u32 v3, 128, v1
    v_lshrrev_b32 v4, 5, v3
    v_and_b32 v3, 31, v3
    v_lshl_add_u32 v3, v3, 4, v2
    v_mad_u32_u24 v92, v4, s3, v3
    v_mov_b32_dpp v240, v224 row_newbcast:15 row_mask:0xf bank_mask:0xf
    v_mov_b32_dpp v241, v225 row_newbcast:15 row_mask:0xf bank_mask:0xf
    v_mov_b32_dpp v242, v226 row_newbcast:15 row_mask:0xf bank_mask:0xf
    v_mov_b32_dpp v243, v227 row_newbcast:15 row_mask:0xf bank_mask:0xf
    v_mov_b32_dpp v244, v228 row_newbcast:15 row_mask:0xf bank_mask:0xf
    v_mov_b32_dpp v245, v229 row_newbcast:15 row_mask:0xf bank_mask:0xf
    v_mov_b32_dpp v246, v230 row_newbcast:15 row_mask:0xf bank_mask:0xf
    v_mov_b32_dpp v247, v231 row_newbcast:15 row_mask:0xf bank_mask:0xf
    v_mov_b32_dpp v248, v232 row_newbcast:15 row_mask:0xf bank_mask:0xf
    v_mov_b32_dpp v249, v233 row_newbcast:15 row_mask:0xf bank_mask:0xf
    v_mov_b32_dpp v250, v234 row_newbcast:15 row_mask:0xf bank_mask:0xf
    v_mov_b32_dpp v251, v235 row_newbcast:15 row_mask:0xf bank_mask:0xf
    v_mov_b32_dpp v252, v236 row_newbcast:15 row_mask:0xf bank_mask:0xf
    v_mov_b32_dpp v253, v237 row_newbcast:15 row_mask:0xf bank_mask:0xf
    v_mov_b32_dpp v254, v238 row_newbcast:15 row_mask:0xf bank_mask:0xf
    v_mov_b32_dpp v255, v239 row_newbcast:15 row_mask:0xf bank_mask:0xf
    s_barrier
    v_lshlrev_b32 v1, 3, v13
    v_add_u32 v1, 153600, v1
    ds_read_b64 v[20:21], v1 offset:0
    ds_read_b64 v[22:23], v1 offset:128
    ds_read_b64 v[24:25], v1 offset:256
    ds_read_b64 v[26:27], v1 offset:384
    ds_read_b64 v[28:29], v1 offset:512
    ds_read_b64 v[30:31], v1 offset:640
    ds_read_b64 v[32:33], v1 offset:768
    ds_read_b64 v[34:35], v1 offset:896
    ds_read_b64 v[36:37], v1 offset:1024
    s_cmp_ge_u32 s45, 6
    s_cbranch_scc1 proj_kernel_ffn
    s_mov_b32 s50, 1.0
    s_cmp_lt_u32 s45, 2
    s_cselect_b32 s50, 0x3eb8aa3b, s50
    v_lshlrev_b32 v1, 5, v13
    v_lshl_add_u32 v1, v14, 3, v1
    v_add_u32 v2, 4096, v1
    s_lshl_b32 s51, s45, 4
    s_lshl_b32 s3, s46, 1
    s_add_u32 s51, s51, s3
    s_lshl_b32 s51, s51, 16
    s_mul_i32 s3, s44, 4576
    s_add_u32 s51, s51, s3
    s_add_u32 s52, s51, 0x10000
    s_add_u32 s53, s51, 0x80000
    s_add_u32 s54, s51, 0x90000
    s_waitcnt lgkmcnt(0)
    v_mul_f32 v21, s50, v21
    v_mul_f32 v23, s50, v23
    v_mul_f32 v25, s50, v25
    v_mul_f32 v27, s50, v27
    v_mul_f32 v29, s50, v29
    v_mul_f32 v31, s50, v31
    v_mul_f32 v33, s50, v33
    v_mul_f32 v35, s50, v35
    v_mul_f32 v37, s50, v37
    v_pk_fma_f32 v[96:97], v[240:241], v[20:21], v[96:97] op_sel_hi:[1,0,1] neg_lo:[0,1,0] neg_hi:[0,1,0]
    v_pk_fma_f32 v[98:99], v[242:243], v[20:21], v[98:99] op_sel_hi:[1,0,1] neg_lo:[0,1,0] neg_hi:[0,1,0]
    v_pk_fma_f32 v[100:101], v[244:245], v[20:21], v[100:101] op_sel_hi:[1,0,1] neg_lo:[0,1,0] neg_hi:[0,1,0]
    v_pk_fma_f32 v[102:103], v[246:247], v[20:21], v[102:103] op_sel_hi:[1,0,1] neg_lo:[0,1,0] neg_hi:[0,1,0]
    v_pk_fma_f32 v[104:105], v[248:249], v[20:21], v[104:105] op_sel_hi:[1,0,1] neg_lo:[0,1,0] neg_hi:[0,1,0]
    v_pk_fma_f32 v[106:107], v[250:251], v[20:21], v[106:107] op_sel_hi:[1,0,1] neg_lo:[0,1,0] neg_hi:[0,1,0]
    v_pk_fma_f32 v[108:109], v[252:253], v[20:21], v[108:109] op_sel_hi:[1,0,1] neg_lo:[0,1,0] neg_hi:[0,1,0]
    v_pk_fma_f32 v[110:111], v[254:255], v[20:21], v[110:111] op_sel_hi:[1,0,1] neg_lo:[0,1,0] neg_hi:[0,1,0]
    v_pk_mul_f32 v[96:97], v[96:97], v[20:21] op_sel:[0,1] op_sel_hi:[1,1]
    v_pk_mul_f32 v[98:99], v[98:99], v[20:21] op_sel:[0,1] op_sel_hi:[1,1]
    v_pk_mul_f32 v[100:101], v[100:101], v[20:21] op_sel:[0,1] op_sel_hi:[1,1]
    v_pk_mul_f32 v[102:103], v[102:103], v[20:21] op_sel:[0,1] op_sel_hi:[1,1]
    v_pk_mul_f32 v[104:105], v[104:105], v[20:21] op_sel:[0,1] op_sel_hi:[1,1]
    v_pk_mul_f32 v[106:107], v[106:107], v[20:21] op_sel:[0,1] op_sel_hi:[1,1]
    v_pk_mul_f32 v[108:109], v[108:109], v[20:21] op_sel:[0,1] op_sel_hi:[1,1]
    v_pk_mul_f32 v[110:111], v[110:111], v[20:21] op_sel:[0,1] op_sel_hi:[1,1]
    v_cvt_pk_bf16_f32 v96, v96, v97
    v_cvt_pk_bf16_f32 v97, v98, v99
    v_cvt_pk_bf16_f32 v98, v100, v101
    v_cvt_pk_bf16_f32 v99, v102, v103
    v_cvt_pk_bf16_f32 v100, v104, v105
    v_cvt_pk_bf16_f32 v101, v106, v107
    v_cvt_pk_bf16_f32 v102, v108, v109
    v_cvt_pk_bf16_f32 v103, v110, v111
    buffer_store_dwordx2 v[96:97], v1, s[36:39], s51 offen offset:0
    buffer_store_dwordx2 v[98:99], v1, s[36:39], s52 offen offset:0
    buffer_store_dwordx2 v[100:101], v1, s[36:39], s53 offen offset:0
    buffer_store_dwordx2 v[102:103], v1, s[36:39], s54 offen offset:0
    v_pk_fma_f32 v[112:113], v[240:241], v[22:23], v[112:113] op_sel_hi:[1,0,1] neg_lo:[0,1,0] neg_hi:[0,1,0]
    v_pk_fma_f32 v[114:115], v[242:243], v[22:23], v[114:115] op_sel_hi:[1,0,1] neg_lo:[0,1,0] neg_hi:[0,1,0]
    v_pk_fma_f32 v[116:117], v[244:245], v[22:23], v[116:117] op_sel_hi:[1,0,1] neg_lo:[0,1,0] neg_hi:[0,1,0]
    v_pk_fma_f32 v[118:119], v[246:247], v[22:23], v[118:119] op_sel_hi:[1,0,1] neg_lo:[0,1,0] neg_hi:[0,1,0]
    v_pk_fma_f32 v[120:121], v[248:249], v[22:23], v[120:121] op_sel_hi:[1,0,1] neg_lo:[0,1,0] neg_hi:[0,1,0]
    v_pk_fma_f32 v[122:123], v[250:251], v[22:23], v[122:123] op_sel_hi:[1,0,1] neg_lo:[0,1,0] neg_hi:[0,1,0]
    v_pk_fma_f32 v[124:125], v[252:253], v[22:23], v[124:125] op_sel_hi:[1,0,1] neg_lo:[0,1,0] neg_hi:[0,1,0]
    v_pk_fma_f32 v[126:127], v[254:255], v[22:23], v[126:127] op_sel_hi:[1,0,1] neg_lo:[0,1,0] neg_hi:[0,1,0]
    v_pk_mul_f32 v[112:113], v[112:113], v[22:23] op_sel:[0,1] op_sel_hi:[1,1]
    v_pk_mul_f32 v[114:115], v[114:115], v[22:23] op_sel:[0,1] op_sel_hi:[1,1]
    v_pk_mul_f32 v[116:117], v[116:117], v[22:23] op_sel:[0,1] op_sel_hi:[1,1]
    v_pk_mul_f32 v[118:119], v[118:119], v[22:23] op_sel:[0,1] op_sel_hi:[1,1]
    v_pk_mul_f32 v[120:121], v[120:121], v[22:23] op_sel:[0,1] op_sel_hi:[1,1]
    v_pk_mul_f32 v[122:123], v[122:123], v[22:23] op_sel:[0,1] op_sel_hi:[1,1]
    v_pk_mul_f32 v[124:125], v[124:125], v[22:23] op_sel:[0,1] op_sel_hi:[1,1]
    v_pk_mul_f32 v[126:127], v[126:127], v[22:23] op_sel:[0,1] op_sel_hi:[1,1]
    v_cvt_pk_bf16_f32 v112, v112, v113
    v_cvt_pk_bf16_f32 v113, v114, v115
    v_cvt_pk_bf16_f32 v114, v116, v117
    v_cvt_pk_bf16_f32 v115, v118, v119
    v_cvt_pk_bf16_f32 v116, v120, v121
    v_cvt_pk_bf16_f32 v117, v122, v123
    v_cvt_pk_bf16_f32 v118, v124, v125
    v_cvt_pk_bf16_f32 v119, v126, v127
    buffer_store_dwordx2 v[112:113], v1, s[36:39], s51 offen offset:512
    buffer_store_dwordx2 v[114:115], v1, s[36:39], s52 offen offset:512
    buffer_store_dwordx2 v[116:117], v1, s[36:39], s53 offen offset:512
    buffer_store_dwordx2 v[118:119], v1, s[36:39], s54 offen offset:512
    v_pk_fma_f32 v[128:129], v[240:241], v[24:25], v[128:129] op_sel_hi:[1,0,1] neg_lo:[0,1,0] neg_hi:[0,1,0]
    v_pk_fma_f32 v[130:131], v[242:243], v[24:25], v[130:131] op_sel_hi:[1,0,1] neg_lo:[0,1,0] neg_hi:[0,1,0]
    v_pk_fma_f32 v[132:133], v[244:245], v[24:25], v[132:133] op_sel_hi:[1,0,1] neg_lo:[0,1,0] neg_hi:[0,1,0]
    v_pk_fma_f32 v[134:135], v[246:247], v[24:25], v[134:135] op_sel_hi:[1,0,1] neg_lo:[0,1,0] neg_hi:[0,1,0]
    v_pk_fma_f32 v[136:137], v[248:249], v[24:25], v[136:137] op_sel_hi:[1,0,1] neg_lo:[0,1,0] neg_hi:[0,1,0]
    v_pk_fma_f32 v[138:139], v[250:251], v[24:25], v[138:139] op_sel_hi:[1,0,1] neg_lo:[0,1,0] neg_hi:[0,1,0]
    v_pk_fma_f32 v[140:141], v[252:253], v[24:25], v[140:141] op_sel_hi:[1,0,1] neg_lo:[0,1,0] neg_hi:[0,1,0]
    v_pk_fma_f32 v[142:143], v[254:255], v[24:25], v[142:143] op_sel_hi:[1,0,1] neg_lo:[0,1,0] neg_hi:[0,1,0]
    v_pk_mul_f32 v[128:129], v[128:129], v[24:25] op_sel:[0,1] op_sel_hi:[1,1]
    v_pk_mul_f32 v[130:131], v[130:131], v[24:25] op_sel:[0,1] op_sel_hi:[1,1]
    v_pk_mul_f32 v[132:133], v[132:133], v[24:25] op_sel:[0,1] op_sel_hi:[1,1]
    v_pk_mul_f32 v[134:135], v[134:135], v[24:25] op_sel:[0,1] op_sel_hi:[1,1]
    v_pk_mul_f32 v[136:137], v[136:137], v[24:25] op_sel:[0,1] op_sel_hi:[1,1]
    v_pk_mul_f32 v[138:139], v[138:139], v[24:25] op_sel:[0,1] op_sel_hi:[1,1]
    v_pk_mul_f32 v[140:141], v[140:141], v[24:25] op_sel:[0,1] op_sel_hi:[1,1]
    v_pk_mul_f32 v[142:143], v[142:143], v[24:25] op_sel:[0,1] op_sel_hi:[1,1]
    v_cvt_pk_bf16_f32 v128, v128, v129
    v_cvt_pk_bf16_f32 v129, v130, v131
    v_cvt_pk_bf16_f32 v130, v132, v133
    v_cvt_pk_bf16_f32 v131, v134, v135
    v_cvt_pk_bf16_f32 v132, v136, v137
    v_cvt_pk_bf16_f32 v133, v138, v139
    v_cvt_pk_bf16_f32 v134, v140, v141
    v_cvt_pk_bf16_f32 v135, v142, v143
    s_mov_b64 exec, s[56:57]
    buffer_store_dwordx2 v[128:129], v1, s[36:39], s51 offen offset:1024
    buffer_store_dwordx2 v[130:131], v1, s[36:39], s52 offen offset:1024
    buffer_store_dwordx2 v[132:133], v1, s[36:39], s53 offen offset:1024
    buffer_store_dwordx2 v[134:135], v1, s[36:39], s54 offen offset:1024
    s_cmp_eq_u32 s44, 14
    s_cbranch_scc1 proj_kernel_end
    v_pk_fma_f32 v[144:145], v[240:241], v[26:27], v[144:145] op_sel_hi:[1,0,1] neg_lo:[0,1,0] neg_hi:[0,1,0]
    v_pk_fma_f32 v[146:147], v[242:243], v[26:27], v[146:147] op_sel_hi:[1,0,1] neg_lo:[0,1,0] neg_hi:[0,1,0]
    v_pk_fma_f32 v[148:149], v[244:245], v[26:27], v[148:149] op_sel_hi:[1,0,1] neg_lo:[0,1,0] neg_hi:[0,1,0]
    v_pk_fma_f32 v[150:151], v[246:247], v[26:27], v[150:151] op_sel_hi:[1,0,1] neg_lo:[0,1,0] neg_hi:[0,1,0]
    v_pk_fma_f32 v[152:153], v[248:249], v[26:27], v[152:153] op_sel_hi:[1,0,1] neg_lo:[0,1,0] neg_hi:[0,1,0]
    v_pk_fma_f32 v[154:155], v[250:251], v[26:27], v[154:155] op_sel_hi:[1,0,1] neg_lo:[0,1,0] neg_hi:[0,1,0]
    v_pk_fma_f32 v[156:157], v[252:253], v[26:27], v[156:157] op_sel_hi:[1,0,1] neg_lo:[0,1,0] neg_hi:[0,1,0]
    v_pk_fma_f32 v[158:159], v[254:255], v[26:27], v[158:159] op_sel_hi:[1,0,1] neg_lo:[0,1,0] neg_hi:[0,1,0]
    v_pk_mul_f32 v[144:145], v[144:145], v[26:27] op_sel:[0,1] op_sel_hi:[1,1]
    v_pk_mul_f32 v[146:147], v[146:147], v[26:27] op_sel:[0,1] op_sel_hi:[1,1]
    v_pk_mul_f32 v[148:149], v[148:149], v[26:27] op_sel:[0,1] op_sel_hi:[1,1]
    v_pk_mul_f32 v[150:151], v[150:151], v[26:27] op_sel:[0,1] op_sel_hi:[1,1]
    v_pk_mul_f32 v[152:153], v[152:153], v[26:27] op_sel:[0,1] op_sel_hi:[1,1]
    v_pk_mul_f32 v[154:155], v[154:155], v[26:27] op_sel:[0,1] op_sel_hi:[1,1]
    v_pk_mul_f32 v[156:157], v[156:157], v[26:27] op_sel:[0,1] op_sel_hi:[1,1]
    v_pk_mul_f32 v[158:159], v[158:159], v[26:27] op_sel:[0,1] op_sel_hi:[1,1]
    v_cvt_pk_bf16_f32 v144, v144, v145
    v_cvt_pk_bf16_f32 v145, v146, v147
    v_cvt_pk_bf16_f32 v146, v148, v149
    v_cvt_pk_bf16_f32 v147, v150, v151
    v_cvt_pk_bf16_f32 v148, v152, v153
    v_cvt_pk_bf16_f32 v149, v154, v155
    v_cvt_pk_bf16_f32 v150, v156, v157
    v_cvt_pk_bf16_f32 v151, v158, v159
    buffer_store_dwordx2 v[144:145], v1, s[36:39], s51 offen offset:1536
    buffer_store_dwordx2 v[146:147], v1, s[36:39], s52 offen offset:1536
    buffer_store_dwordx2 v[148:149], v1, s[36:39], s53 offen offset:1536
    buffer_store_dwordx2 v[150:151], v1, s[36:39], s54 offen offset:1536
    v_pk_fma_f32 v[160:161], v[240:241], v[28:29], v[160:161] op_sel_hi:[1,0,1] neg_lo:[0,1,0] neg_hi:[0,1,0]
    v_pk_fma_f32 v[162:163], v[242:243], v[28:29], v[162:163] op_sel_hi:[1,0,1] neg_lo:[0,1,0] neg_hi:[0,1,0]
    v_pk_fma_f32 v[164:165], v[244:245], v[28:29], v[164:165] op_sel_hi:[1,0,1] neg_lo:[0,1,0] neg_hi:[0,1,0]
    v_pk_fma_f32 v[166:167], v[246:247], v[28:29], v[166:167] op_sel_hi:[1,0,1] neg_lo:[0,1,0] neg_hi:[0,1,0]
    v_pk_fma_f32 v[168:169], v[248:249], v[28:29], v[168:169] op_sel_hi:[1,0,1] neg_lo:[0,1,0] neg_hi:[0,1,0]
    v_pk_fma_f32 v[170:171], v[250:251], v[28:29], v[170:171] op_sel_hi:[1,0,1] neg_lo:[0,1,0] neg_hi:[0,1,0]
    v_pk_fma_f32 v[172:173], v[252:253], v[28:29], v[172:173] op_sel_hi:[1,0,1] neg_lo:[0,1,0] neg_hi:[0,1,0]
    v_pk_fma_f32 v[174:175], v[254:255], v[28:29], v[174:175] op_sel_hi:[1,0,1] neg_lo:[0,1,0] neg_hi:[0,1,0]
    v_pk_mul_f32 v[160:161], v[160:161], v[28:29] op_sel:[0,1] op_sel_hi:[1,1]
    v_pk_mul_f32 v[162:163], v[162:163], v[28:29] op_sel:[0,1] op_sel_hi:[1,1]
    v_pk_mul_f32 v[164:165], v[164:165], v[28:29] op_sel:[0,1] op_sel_hi:[1,1]
    v_pk_mul_f32 v[166:167], v[166:167], v[28:29] op_sel:[0,1] op_sel_hi:[1,1]
    v_pk_mul_f32 v[168:169], v[168:169], v[28:29] op_sel:[0,1] op_sel_hi:[1,1]
    v_pk_mul_f32 v[170:171], v[170:171], v[28:29] op_sel:[0,1] op_sel_hi:[1,1]
    v_pk_mul_f32 v[172:173], v[172:173], v[28:29] op_sel:[0,1] op_sel_hi:[1,1]
    v_pk_mul_f32 v[174:175], v[174:175], v[28:29] op_sel:[0,1] op_sel_hi:[1,1]
    v_cvt_pk_bf16_f32 v160, v160, v161
    v_cvt_pk_bf16_f32 v161, v162, v163
    v_cvt_pk_bf16_f32 v162, v164, v165
    v_cvt_pk_bf16_f32 v163, v166, v167
    v_cvt_pk_bf16_f32 v164, v168, v169
    v_cvt_pk_bf16_f32 v165, v170, v171
    v_cvt_pk_bf16_f32 v166, v172, v173
    v_cvt_pk_bf16_f32 v167, v174, v175
    buffer_store_dwordx2 v[160:161], v1, s[36:39], s51 offen offset:2048
    buffer_store_dwordx2 v[162:163], v1, s[36:39], s52 offen offset:2048
    buffer_store_dwordx2 v[164:165], v1, s[36:39], s53 offen offset:2048
    buffer_store_dwordx2 v[166:167], v1, s[36:39], s54 offen offset:2048
    v_pk_fma_f32 v[176:177], v[240:241], v[30:31], v[176:177] op_sel_hi:[1,0,1] neg_lo:[0,1,0] neg_hi:[0,1,0]
    v_pk_fma_f32 v[178:179], v[242:243], v[30:31], v[178:179] op_sel_hi:[1,0,1] neg_lo:[0,1,0] neg_hi:[0,1,0]
    v_pk_fma_f32 v[180:181], v[244:245], v[30:31], v[180:181] op_sel_hi:[1,0,1] neg_lo:[0,1,0] neg_hi:[0,1,0]
    v_pk_fma_f32 v[182:183], v[246:247], v[30:31], v[182:183] op_sel_hi:[1,0,1] neg_lo:[0,1,0] neg_hi:[0,1,0]
    v_pk_fma_f32 v[184:185], v[248:249], v[30:31], v[184:185] op_sel_hi:[1,0,1] neg_lo:[0,1,0] neg_hi:[0,1,0]
    v_pk_fma_f32 v[186:187], v[250:251], v[30:31], v[186:187] op_sel_hi:[1,0,1] neg_lo:[0,1,0] neg_hi:[0,1,0]
    v_pk_fma_f32 v[188:189], v[252:253], v[30:31], v[188:189] op_sel_hi:[1,0,1] neg_lo:[0,1,0] neg_hi:[0,1,0]
    v_pk_fma_f32 v[190:191], v[254:255], v[30:31], v[190:191] op_sel_hi:[1,0,1] neg_lo:[0,1,0] neg_hi:[0,1,0]
    v_pk_mul_f32 v[176:177], v[176:177], v[30:31] op_sel:[0,1] op_sel_hi:[1,1]
    v_pk_mul_f32 v[178:179], v[178:179], v[30:31] op_sel:[0,1] op_sel_hi:[1,1]
    v_pk_mul_f32 v[180:181], v[180:181], v[30:31] op_sel:[0,1] op_sel_hi:[1,1]
    v_pk_mul_f32 v[182:183], v[182:183], v[30:31] op_sel:[0,1] op_sel_hi:[1,1]
    v_pk_mul_f32 v[184:185], v[184:185], v[30:31] op_sel:[0,1] op_sel_hi:[1,1]
    v_pk_mul_f32 v[186:187], v[186:187], v[30:31] op_sel:[0,1] op_sel_hi:[1,1]
    v_pk_mul_f32 v[188:189], v[188:189], v[30:31] op_sel:[0,1] op_sel_hi:[1,1]
    v_pk_mul_f32 v[190:191], v[190:191], v[30:31] op_sel:[0,1] op_sel_hi:[1,1]
    v_cvt_pk_bf16_f32 v176, v176, v177
    v_cvt_pk_bf16_f32 v177, v178, v179
    v_cvt_pk_bf16_f32 v178, v180, v181
    v_cvt_pk_bf16_f32 v179, v182, v183
    v_cvt_pk_bf16_f32 v180, v184, v185
    v_cvt_pk_bf16_f32 v181, v186, v187
    v_cvt_pk_bf16_f32 v182, v188, v189
    v_cvt_pk_bf16_f32 v183, v190, v191
    buffer_store_dwordx2 v[176:177], v1, s[36:39], s51 offen offset:2560
    buffer_store_dwordx2 v[178:179], v1, s[36:39], s52 offen offset:2560
    buffer_store_dwordx2 v[180:181], v1, s[36:39], s53 offen offset:2560
    buffer_store_dwordx2 v[182:183], v1, s[36:39], s54 offen offset:2560
    v_pk_fma_f32 v[192:193], v[240:241], v[32:33], v[192:193] op_sel_hi:[1,0,1] neg_lo:[0,1,0] neg_hi:[0,1,0]
    v_pk_fma_f32 v[194:195], v[242:243], v[32:33], v[194:195] op_sel_hi:[1,0,1] neg_lo:[0,1,0] neg_hi:[0,1,0]
    v_pk_fma_f32 v[196:197], v[244:245], v[32:33], v[196:197] op_sel_hi:[1,0,1] neg_lo:[0,1,0] neg_hi:[0,1,0]
    v_pk_fma_f32 v[198:199], v[246:247], v[32:33], v[198:199] op_sel_hi:[1,0,1] neg_lo:[0,1,0] neg_hi:[0,1,0]
    v_pk_fma_f32 v[200:201], v[248:249], v[32:33], v[200:201] op_sel_hi:[1,0,1] neg_lo:[0,1,0] neg_hi:[0,1,0]
    v_pk_fma_f32 v[202:203], v[250:251], v[32:33], v[202:203] op_sel_hi:[1,0,1] neg_lo:[0,1,0] neg_hi:[0,1,0]
    v_pk_fma_f32 v[204:205], v[252:253], v[32:33], v[204:205] op_sel_hi:[1,0,1] neg_lo:[0,1,0] neg_hi:[0,1,0]
    v_pk_fma_f32 v[206:207], v[254:255], v[32:33], v[206:207] op_sel_hi:[1,0,1] neg_lo:[0,1,0] neg_hi:[0,1,0]
    v_pk_mul_f32 v[192:193], v[192:193], v[32:33] op_sel:[0,1] op_sel_hi:[1,1]
    v_pk_mul_f32 v[194:195], v[194:195], v[32:33] op_sel:[0,1] op_sel_hi:[1,1]
    v_pk_mul_f32 v[196:197], v[196:197], v[32:33] op_sel:[0,1] op_sel_hi:[1,1]
    v_pk_mul_f32 v[198:199], v[198:199], v[32:33] op_sel:[0,1] op_sel_hi:[1,1]
    v_pk_mul_f32 v[200:201], v[200:201], v[32:33] op_sel:[0,1] op_sel_hi:[1,1]
    v_pk_mul_f32 v[202:203], v[202:203], v[32:33] op_sel:[0,1] op_sel_hi:[1,1]
    v_pk_mul_f32 v[204:205], v[204:205], v[32:33] op_sel:[0,1] op_sel_hi:[1,1]
    v_pk_mul_f32 v[206:207], v[206:207], v[32:33] op_sel:[0,1] op_sel_hi:[1,1]
    v_cvt_pk_bf16_f32 v192, v192, v193
    v_cvt_pk_bf16_f32 v193, v194, v195
    v_cvt_pk_bf16_f32 v194, v196, v197
    v_cvt_pk_bf16_f32 v195, v198, v199
    v_cvt_pk_bf16_f32 v196, v200, v201
    v_cvt_pk_bf16_f32 v197, v202, v203
    v_cvt_pk_bf16_f32 v198, v204, v205
    v_cvt_pk_bf16_f32 v199, v206, v207
    buffer_store_dwordx2 v[192:193], v1, s[36:39], s51 offen offset:3072
    buffer_store_dwordx2 v[194:195], v1, s[36:39], s52 offen offset:3072
    buffer_store_dwordx2 v[196:197], v1, s[36:39], s53 offen offset:3072
    buffer_store_dwordx2 v[198:199], v1, s[36:39], s54 offen offset:3072
    v_pk_fma_f32 v[208:209], v[240:241], v[34:35], v[208:209] op_sel_hi:[1,0,1] neg_lo:[0,1,0] neg_hi:[0,1,0]
    v_pk_fma_f32 v[210:211], v[242:243], v[34:35], v[210:211] op_sel_hi:[1,0,1] neg_lo:[0,1,0] neg_hi:[0,1,0]
    v_pk_fma_f32 v[212:213], v[244:245], v[34:35], v[212:213] op_sel_hi:[1,0,1] neg_lo:[0,1,0] neg_hi:[0,1,0]
    v_pk_fma_f32 v[214:215], v[246:247], v[34:35], v[214:215] op_sel_hi:[1,0,1] neg_lo:[0,1,0] neg_hi:[0,1,0]
    v_pk_fma_f32 v[216:217], v[248:249], v[34:35], v[216:217] op_sel_hi:[1,0,1] neg_lo:[0,1,0] neg_hi:[0,1,0]
    v_pk_fma_f32 v[218:219], v[250:251], v[34:35], v[218:219] op_sel_hi:[1,0,1] neg_lo:[0,1,0] neg_hi:[0,1,0]
    v_pk_fma_f32 v[220:221], v[252:253], v[34:35], v[220:221] op_sel_hi:[1,0,1] neg_lo:[0,1,0] neg_hi:[0,1,0]
    v_pk_fma_f32 v[222:223], v[254:255], v[34:35], v[222:223] op_sel_hi:[1,0,1] neg_lo:[0,1,0] neg_hi:[0,1,0]
    v_pk_mul_f32 v[208:209], v[208:209], v[34:35] op_sel:[0,1] op_sel_hi:[1,1]
    v_pk_mul_f32 v[210:211], v[210:211], v[34:35] op_sel:[0,1] op_sel_hi:[1,1]
    v_pk_mul_f32 v[212:213], v[212:213], v[34:35] op_sel:[0,1] op_sel_hi:[1,1]
    v_pk_mul_f32 v[214:215], v[214:215], v[34:35] op_sel:[0,1] op_sel_hi:[1,1]
    v_pk_mul_f32 v[216:217], v[216:217], v[34:35] op_sel:[0,1] op_sel_hi:[1,1]
    v_pk_mul_f32 v[218:219], v[218:219], v[34:35] op_sel:[0,1] op_sel_hi:[1,1]
    v_pk_mul_f32 v[220:221], v[220:221], v[34:35] op_sel:[0,1] op_sel_hi:[1,1]
    v_pk_mul_f32 v[222:223], v[222:223], v[34:35] op_sel:[0,1] op_sel_hi:[1,1]
    v_cvt_pk_bf16_f32 v208, v208, v209
    v_cvt_pk_bf16_f32 v209, v210, v211
    v_cvt_pk_bf16_f32 v210, v212, v213
    v_cvt_pk_bf16_f32 v211, v214, v215
    v_cvt_pk_bf16_f32 v212, v216, v217
    v_cvt_pk_bf16_f32 v213, v218, v219
    v_cvt_pk_bf16_f32 v214, v220, v221
    v_cvt_pk_bf16_f32 v215, v222, v223
    buffer_store_dwordx2 v[208:209], v1, s[36:39], s51 offen offset:3584
    buffer_store_dwordx2 v[210:211], v1, s[36:39], s52 offen offset:3584
    buffer_store_dwordx2 v[212:213], v1, s[36:39], s53 offen offset:3584
    buffer_store_dwordx2 v[214:215], v1, s[36:39], s54 offen offset:3584
    v_pk_fma_f32 v[224:225], v[240:241], v[36:37], v[224:225] op_sel_hi:[1,0,1] neg_lo:[0,1,0] neg_hi:[0,1,0]
    v_pk_fma_f32 v[226:227], v[242:243], v[36:37], v[226:227] op_sel_hi:[1,0,1] neg_lo:[0,1,0] neg_hi:[0,1,0]
    v_pk_fma_f32 v[228:229], v[244:245], v[36:37], v[228:229] op_sel_hi:[1,0,1] neg_lo:[0,1,0] neg_hi:[0,1,0]
    v_pk_fma_f32 v[230:231], v[246:247], v[36:37], v[230:231] op_sel_hi:[1,0,1] neg_lo:[0,1,0] neg_hi:[0,1,0]
    v_pk_fma_f32 v[232:233], v[248:249], v[36:37], v[232:233] op_sel_hi:[1,0,1] neg_lo:[0,1,0] neg_hi:[0,1,0]
    v_pk_fma_f32 v[234:235], v[250:251], v[36:37], v[234:235] op_sel_hi:[1,0,1] neg_lo:[0,1,0] neg_hi:[0,1,0]
    v_pk_fma_f32 v[236:237], v[252:253], v[36:37], v[236:237] op_sel_hi:[1,0,1] neg_lo:[0,1,0] neg_hi:[0,1,0]
    v_pk_fma_f32 v[238:239], v[254:255], v[36:37], v[238:239] op_sel_hi:[1,0,1] neg_lo:[0,1,0] neg_hi:[0,1,0]
    v_pk_mul_f32 v[224:225], v[224:225], v[36:37] op_sel:[0,1] op_sel_hi:[1,1]
    v_pk_mul_f32 v[226:227], v[226:227], v[36:37] op_sel:[0,1] op_sel_hi:[1,1]
    v_pk_mul_f32 v[228:229], v[228:229], v[36:37] op_sel:[0,1] op_sel_hi:[1,1]
    v_pk_mul_f32 v[230:231], v[230:231], v[36:37] op_sel:[0,1] op_sel_hi:[1,1]
    v_pk_mul_f32 v[232:233], v[232:233], v[36:37] op_sel:[0,1] op_sel_hi:[1,1]
    v_pk_mul_f32 v[234:235], v[234:235], v[36:37] op_sel:[0,1] op_sel_hi:[1,1]
    v_pk_mul_f32 v[236:237], v[236:237], v[36:37] op_sel:[0,1] op_sel_hi:[1,1]
    v_pk_mul_f32 v[238:239], v[238:239], v[36:37] op_sel:[0,1] op_sel_hi:[1,1]
    v_cvt_pk_bf16_f32 v224, v224, v225
    v_cvt_pk_bf16_f32 v225, v226, v227
    v_cvt_pk_bf16_f32 v226, v228, v229
    v_cvt_pk_bf16_f32 v227, v230, v231
    v_cvt_pk_bf16_f32 v228, v232, v233
    v_cvt_pk_bf16_f32 v229, v234, v235
    v_cvt_pk_bf16_f32 v230, v236, v237
    v_cvt_pk_bf16_f32 v231, v238, v239
    s_mov_b64 exec, s[58:59]
    buffer_store_dwordx2 v[224:225], v2, s[36:39], s51 offen offset:0
    buffer_store_dwordx2 v[226:227], v2, s[36:39], s52 offen offset:0
    buffer_store_dwordx2 v[228:229], v2, s[36:39], s53 offen offset:0
    buffer_store_dwordx2 v[230:231], v2, s[36:39], s54 offen offset:0
    s_endpgm
proj_kernel_ffn:
    s_cmp_eq_u32 s45, 16
    s_cselect_b32 s3, 3, 7
    s_cmp_eq_u32 s46, s3
    s_cbranch_scc1 proj_kernel_end
    s_sub_u32 s51, s45, 6
    s_lshl_b32 s51, s51, 2
    s_add_u32 s51, s51, s46
    s_lshl_b32 s51, s51, 11
    s_add_u32 s51, s51, 6291456
    s_mov_b32 s50, 0xbfb8aa3b
    s_waitcnt lgkmcnt(0)
    v_mul_f32 v44, s50, v21
    v_mul_f32 v45, v21, v21
    v_mul_f32 v46, s50, v23
    v_mul_f32 v47, v23, v23
    v_mul_f32 v48, s50, v25
    v_mul_f32 v49, v25, v25
    v_mul_f32 v50, s50, v27
    v_mul_f32 v51, v27, v27
    v_mul_f32 v52, s50, v29
    v_mul_f32 v53, v29, v29
    v_mul_f32 v54, s50, v31
    v_mul_f32 v55, v31, v31
    v_mul_f32 v56, s50, v33
    v_mul_f32 v57, v33, v33
    v_mul_f32 v58, s50, v35
    v_mul_f32 v59, v35, v35
    v_mul_f32 v60, s50, v37
    v_mul_f32 v61, v37, v37
    v_rcp_f32 v45, v45
    v_rcp_f32 v47, v47
    v_rcp_f32 v49, v49
    v_rcp_f32 v51, v51
    v_rcp_f32 v53, v53
    v_rcp_f32 v55, v55
    v_rcp_f32 v57, v57
    v_rcp_f32 v59, v59
    v_rcp_f32 v61, v61
    v_pk_fma_f32 v[96:97], v[240:241], v[20:21], v[96:97] op_sel_hi:[1,0,1] neg_lo:[0,1,0] neg_hi:[0,1,0]
    v_pk_fma_f32 v[98:99], v[242:243], v[20:21], v[98:99] op_sel_hi:[1,0,1] neg_lo:[0,1,0] neg_hi:[0,1,0]
    v_pk_fma_f32 v[100:101], v[244:245], v[20:21], v[100:101] op_sel_hi:[1,0,1] neg_lo:[0,1,0] neg_hi:[0,1,0]
    v_pk_fma_f32 v[102:103], v[246:247], v[20:21], v[102:103] op_sel_hi:[1,0,1] neg_lo:[0,1,0] neg_hi:[0,1,0]
    v_pk_fma_f32 v[104:105], v[248:249], v[20:21], v[104:105] op_sel_hi:[1,0,1] neg_lo:[0,1,0] neg_hi:[0,1,0]
    v_pk_fma_f32 v[106:107], v[250:251], v[20:21], v[106:107] op_sel_hi:[1,0,1] neg_lo:[0,1,0] neg_hi:[0,1,0]
    v_pk_fma_f32 v[108:109], v[252:253], v[20:21], v[108:109] op_sel_hi:[1,0,1] neg_lo:[0,1,0] neg_hi:[0,1,0]
    v_pk_fma_f32 v[110:111], v[254:255], v[20:21], v[110:111] op_sel_hi:[1,0,1] neg_lo:[0,1,0] neg_hi:[0,1,0]
    v_pk_mul_f32 v[76:77], v[96:97], v[44:45] op_sel_hi:[1,0]
    v_pk_mul_f32 v[78:79], v[98:99], v[44:45] op_sel_hi:[1,0]
    v_pk_mul_f32 v[80:81], v[100:101], v[44:45] op_sel_hi:[1,0]
    v_pk_mul_f32 v[82:83], v[102:103], v[44:45] op_sel_hi:[1,0]
    v_exp_f32 v76, v76
    v_exp_f32 v77, v77
    v_exp_f32 v78, v78
    v_exp_f32 v79, v79
    v_exp_f32 v80, v80
    v_exp_f32 v81, v81
    v_exp_f32 v82, v82
    v_exp_f32 v83, v83
    v_pk_mul_f32 v[96:97], v[96:97], v[104:105]
    v_pk_mul_f32 v[98:99], v[98:99], v[106:107]
    v_pk_mul_f32 v[100:101], v[100:101], v[108:109]
    v_pk_mul_f32 v[102:103], v[102:103], v[110:111]
    v_pk_fma_f32 v[76:77], v[76:77], v[44:45], v[44:45] op_sel:[0,1,1] op_sel_hi:[1,1,1]
    v_pk_fma_f32 v[78:79], v[78:79], v[44:45], v[44:45] op_sel:[0,1,1] op_sel_hi:[1,1,1]
    v_pk_fma_f32 v[80:81], v[80:81], v[44:45], v[44:45] op_sel:[0,1,1] op_sel_hi:[1,1,1]
    v_pk_fma_f32 v[82:83], v[82:83], v[44:45], v[44:45] op_sel:[0,1,1] op_sel_hi:[1,1,1]
    v_rcp_f32 v76, v76
    v_rcp_f32 v77, v77
    v_rcp_f32 v78, v78
    v_rcp_f32 v79, v79
    v_rcp_f32 v80, v80
    v_rcp_f32 v81, v81
    v_rcp_f32 v82, v82
    v_rcp_f32 v83, v83
    v_pk_mul_f32 v[96:97], v[96:97], v[76:77]
    v_pk_mul_f32 v[98:99], v[98:99], v[78:79]
    v_pk_mul_f32 v[100:101], v[100:101], v[80:81]
    v_pk_mul_f32 v[102:103], v[102:103], v[82:83]
    v_cvt_pk_bf16_f32 v104, v96, v97
    v_cvt_pk_bf16_f32 v105, v98, v99
    v_cvt_pk_bf16_f32 v106, v100, v101
    v_cvt_pk_bf16_f32 v107, v102, v103
    buffer_store_dwordx2 v[104:105], v84, s[36:39], s51 offen offset:0
    buffer_store_dwordx2 v[106:107], v84, s[36:39], s51 offen offset:1024
    v_pk_fma_f32 v[112:113], v[240:241], v[22:23], v[112:113] op_sel_hi:[1,0,1] neg_lo:[0,1,0] neg_hi:[0,1,0]
    v_pk_fma_f32 v[114:115], v[242:243], v[22:23], v[114:115] op_sel_hi:[1,0,1] neg_lo:[0,1,0] neg_hi:[0,1,0]
    v_pk_fma_f32 v[116:117], v[244:245], v[22:23], v[116:117] op_sel_hi:[1,0,1] neg_lo:[0,1,0] neg_hi:[0,1,0]
    v_pk_fma_f32 v[118:119], v[246:247], v[22:23], v[118:119] op_sel_hi:[1,0,1] neg_lo:[0,1,0] neg_hi:[0,1,0]
    v_pk_fma_f32 v[120:121], v[248:249], v[22:23], v[120:121] op_sel_hi:[1,0,1] neg_lo:[0,1,0] neg_hi:[0,1,0]
    v_pk_fma_f32 v[122:123], v[250:251], v[22:23], v[122:123] op_sel_hi:[1,0,1] neg_lo:[0,1,0] neg_hi:[0,1,0]
    v_pk_fma_f32 v[124:125], v[252:253], v[22:23], v[124:125] op_sel_hi:[1,0,1] neg_lo:[0,1,0] neg_hi:[0,1,0]
    v_pk_fma_f32 v[126:127], v[254:255], v[22:23], v[126:127] op_sel_hi:[1,0,1] neg_lo:[0,1,0] neg_hi:[0,1,0]
    v_pk_mul_f32 v[76:77], v[112:113], v[46:47] op_sel_hi:[1,0]
    v_pk_mul_f32 v[78:79], v[114:115], v[46:47] op_sel_hi:[1,0]
    v_pk_mul_f32 v[80:81], v[116:117], v[46:47] op_sel_hi:[1,0]
    v_pk_mul_f32 v[82:83], v[118:119], v[46:47] op_sel_hi:[1,0]
    v_exp_f32 v76, v76
    v_exp_f32 v77, v77
    v_exp_f32 v78, v78
    v_exp_f32 v79, v79
    v_exp_f32 v80, v80
    v_exp_f32 v81, v81
    v_exp_f32 v82, v82
    v_exp_f32 v83, v83
    v_pk_mul_f32 v[112:113], v[112:113], v[120:121]
    v_pk_mul_f32 v[114:115], v[114:115], v[122:123]
    v_pk_mul_f32 v[116:117], v[116:117], v[124:125]
    v_pk_mul_f32 v[118:119], v[118:119], v[126:127]
    v_pk_fma_f32 v[76:77], v[76:77], v[46:47], v[46:47] op_sel:[0,1,1] op_sel_hi:[1,1,1]
    v_pk_fma_f32 v[78:79], v[78:79], v[46:47], v[46:47] op_sel:[0,1,1] op_sel_hi:[1,1,1]
    v_pk_fma_f32 v[80:81], v[80:81], v[46:47], v[46:47] op_sel:[0,1,1] op_sel_hi:[1,1,1]
    v_pk_fma_f32 v[82:83], v[82:83], v[46:47], v[46:47] op_sel:[0,1,1] op_sel_hi:[1,1,1]
    v_rcp_f32 v76, v76
    v_rcp_f32 v77, v77
    v_rcp_f32 v78, v78
    v_rcp_f32 v79, v79
    v_rcp_f32 v80, v80
    v_rcp_f32 v81, v81
    v_rcp_f32 v82, v82
    v_rcp_f32 v83, v83
    v_pk_mul_f32 v[112:113], v[112:113], v[76:77]
    v_pk_mul_f32 v[114:115], v[114:115], v[78:79]
    v_pk_mul_f32 v[116:117], v[116:117], v[80:81]
    v_pk_mul_f32 v[118:119], v[118:119], v[82:83]
    v_cvt_pk_bf16_f32 v120, v112, v113
    v_cvt_pk_bf16_f32 v121, v114, v115
    v_cvt_pk_bf16_f32 v122, v116, v117
    v_cvt_pk_bf16_f32 v123, v118, v119
    buffer_store_dwordx2 v[120:121], v85, s[36:39], s51 offen offset:0
    buffer_store_dwordx2 v[122:123], v85, s[36:39], s51 offen offset:1024
    v_pk_fma_f32 v[128:129], v[240:241], v[24:25], v[128:129] op_sel_hi:[1,0,1] neg_lo:[0,1,0] neg_hi:[0,1,0]
    v_pk_fma_f32 v[130:131], v[242:243], v[24:25], v[130:131] op_sel_hi:[1,0,1] neg_lo:[0,1,0] neg_hi:[0,1,0]
    v_pk_fma_f32 v[132:133], v[244:245], v[24:25], v[132:133] op_sel_hi:[1,0,1] neg_lo:[0,1,0] neg_hi:[0,1,0]
    v_pk_fma_f32 v[134:135], v[246:247], v[24:25], v[134:135] op_sel_hi:[1,0,1] neg_lo:[0,1,0] neg_hi:[0,1,0]
    v_pk_fma_f32 v[136:137], v[248:249], v[24:25], v[136:137] op_sel_hi:[1,0,1] neg_lo:[0,1,0] neg_hi:[0,1,0]
    v_pk_fma_f32 v[138:139], v[250:251], v[24:25], v[138:139] op_sel_hi:[1,0,1] neg_lo:[0,1,0] neg_hi:[0,1,0]
    v_pk_fma_f32 v[140:141], v[252:253], v[24:25], v[140:141] op_sel_hi:[1,0,1] neg_lo:[0,1,0] neg_hi:[0,1,0]
    v_pk_fma_f32 v[142:143], v[254:255], v[24:25], v[142:143] op_sel_hi:[1,0,1] neg_lo:[0,1,0] neg_hi:[0,1,0]
    v_pk_mul_f32 v[76:77], v[128:129], v[48:49] op_sel_hi:[1,0]
    v_pk_mul_f32 v[78:79], v[130:131], v[48:49] op_sel_hi:[1,0]
    v_pk_mul_f32 v[80:81], v[132:133], v[48:49] op_sel_hi:[1,0]
    v_pk_mul_f32 v[82:83], v[134:135], v[48:49] op_sel_hi:[1,0]
    v_exp_f32 v76, v76
    v_exp_f32 v77, v77
    v_exp_f32 v78, v78
    v_exp_f32 v79, v79
    v_exp_f32 v80, v80
    v_exp_f32 v81, v81
    v_exp_f32 v82, v82
    v_exp_f32 v83, v83
    v_pk_mul_f32 v[128:129], v[128:129], v[136:137]
    v_pk_mul_f32 v[130:131], v[130:131], v[138:139]
    v_pk_mul_f32 v[132:133], v[132:133], v[140:141]
    v_pk_mul_f32 v[134:135], v[134:135], v[142:143]
    v_pk_fma_f32 v[76:77], v[76:77], v[48:49], v[48:49] op_sel:[0,1,1] op_sel_hi:[1,1,1]
    v_pk_fma_f32 v[78:79], v[78:79], v[48:49], v[48:49] op_sel:[0,1,1] op_sel_hi:[1,1,1]
    v_pk_fma_f32 v[80:81], v[80:81], v[48:49], v[48:49] op_sel:[0,1,1] op_sel_hi:[1,1,1]
    v_pk_fma_f32 v[82:83], v[82:83], v[48:49], v[48:49] op_sel:[0,1,1] op_sel_hi:[1,1,1]
    v_rcp_f32 v76, v76
    v_rcp_f32 v77, v77
    v_rcp_f32 v78, v78
    v_rcp_f32 v79, v79
    v_rcp_f32 v80, v80
    v_rcp_f32 v81, v81
    v_rcp_f32 v82, v82
    v_rcp_f32 v83, v83
    v_pk_mul_f32 v[128:129], v[128:129], v[76:77]
    v_pk_mul_f32 v[130:131], v[130:131], v[78:79]
    v_pk_mul_f32 v[132:133], v[132:133], v[80:81]
    v_pk_mul_f32 v[134:135], v[134:135], v[82:83]
    v_cvt_pk_bf16_f32 v136, v128, v129
    v_cvt_pk_bf16_f32 v137, v130, v131
    v_cvt_pk_bf16_f32 v138, v132, v133
    v_cvt_pk_bf16_f32 v139, v134, v135
    s_mov_b64 exec, s[56:57]
    buffer_store_dwordx2 v[136:137], v86, s[36:39], s51 offen offset:0
    buffer_store_dwordx2 v[138:139], v86, s[36:39], s51 offen offset:1024
    s_cmp_eq_u32 s44, 14
    s_cbranch_scc1 proj_kernel_end
    v_pk_fma_f32 v[144:145], v[240:241], v[26:27], v[144:145] op_sel_hi:[1,0,1] neg_lo:[0,1,0] neg_hi:[0,1,0]
    v_pk_fma_f32 v[146:147], v[242:243], v[26:27], v[146:147] op_sel_hi:[1,0,1] neg_lo:[0,1,0] neg_hi:[0,1,0]
    v_pk_fma_f32 v[148:149], v[244:245], v[26:27], v[148:149] op_sel_hi:[1,0,1] neg_lo:[0,1,0] neg_hi:[0,1,0]
    v_pk_fma_f32 v[150:151], v[246:247], v[26:27], v[150:151] op_sel_hi:[1,0,1] neg_lo:[0,1,0] neg_hi:[0,1,0]
    v_pk_fma_f32 v[152:153], v[248:249], v[26:27], v[152:153] op_sel_hi:[1,0,1] neg_lo:[0,1,0] neg_hi:[0,1,0]
    v_pk_fma_f32 v[154:155], v[250:251], v[26:27], v[154:155] op_sel_hi:[1,0,1] neg_lo:[0,1,0] neg_hi:[0,1,0]
    v_pk_fma_f32 v[156:157], v[252:253], v[26:27], v[156:157] op_sel_hi:[1,0,1] neg_lo:[0,1,0] neg_hi:[0,1,0]
    v_pk_fma_f32 v[158:159], v[254:255], v[26:27], v[158:159] op_sel_hi:[1,0,1] neg_lo:[0,1,0] neg_hi:[0,1,0]
    v_pk_mul_f32 v[76:77], v[144:145], v[50:51] op_sel_hi:[1,0]
    v_pk_mul_f32 v[78:79], v[146:147], v[50:51] op_sel_hi:[1,0]
    v_pk_mul_f32 v[80:81], v[148:149], v[50:51] op_sel_hi:[1,0]
    v_pk_mul_f32 v[82:83], v[150:151], v[50:51] op_sel_hi:[1,0]
    v_exp_f32 v76, v76
    v_exp_f32 v77, v77
    v_exp_f32 v78, v78
    v_exp_f32 v79, v79
    v_exp_f32 v80, v80
    v_exp_f32 v81, v81
    v_exp_f32 v82, v82
    v_exp_f32 v83, v83
    v_pk_mul_f32 v[144:145], v[144:145], v[152:153]
    v_pk_mul_f32 v[146:147], v[146:147], v[154:155]
    v_pk_mul_f32 v[148:149], v[148:149], v[156:157]
    v_pk_mul_f32 v[150:151], v[150:151], v[158:159]
    v_pk_fma_f32 v[76:77], v[76:77], v[50:51], v[50:51] op_sel:[0,1,1] op_sel_hi:[1,1,1]
    v_pk_fma_f32 v[78:79], v[78:79], v[50:51], v[50:51] op_sel:[0,1,1] op_sel_hi:[1,1,1]
    v_pk_fma_f32 v[80:81], v[80:81], v[50:51], v[50:51] op_sel:[0,1,1] op_sel_hi:[1,1,1]
    v_pk_fma_f32 v[82:83], v[82:83], v[50:51], v[50:51] op_sel:[0,1,1] op_sel_hi:[1,1,1]
    v_rcp_f32 v76, v76
    v_rcp_f32 v77, v77
    v_rcp_f32 v78, v78
    v_rcp_f32 v79, v79
    v_rcp_f32 v80, v80
    v_rcp_f32 v81, v81
    v_rcp_f32 v82, v82
    v_rcp_f32 v83, v83
    v_pk_mul_f32 v[144:145], v[144:145], v[76:77]
    v_pk_mul_f32 v[146:147], v[146:147], v[78:79]
    v_pk_mul_f32 v[148:149], v[148:149], v[80:81]
    v_pk_mul_f32 v[150:151], v[150:151], v[82:83]
    v_cvt_pk_bf16_f32 v152, v144, v145
    v_cvt_pk_bf16_f32 v153, v146, v147
    v_cvt_pk_bf16_f32 v154, v148, v149
    v_cvt_pk_bf16_f32 v155, v150, v151
    buffer_store_dwordx2 v[152:153], v87, s[36:39], s51 offen offset:0
    buffer_store_dwordx2 v[154:155], v87, s[36:39], s51 offen offset:1024
    v_pk_fma_f32 v[160:161], v[240:241], v[28:29], v[160:161] op_sel_hi:[1,0,1] neg_lo:[0,1,0] neg_hi:[0,1,0]
    v_pk_fma_f32 v[162:163], v[242:243], v[28:29], v[162:163] op_sel_hi:[1,0,1] neg_lo:[0,1,0] neg_hi:[0,1,0]
    v_pk_fma_f32 v[164:165], v[244:245], v[28:29], v[164:165] op_sel_hi:[1,0,1] neg_lo:[0,1,0] neg_hi:[0,1,0]
    v_pk_fma_f32 v[166:167], v[246:247], v[28:29], v[166:167] op_sel_hi:[1,0,1] neg_lo:[0,1,0] neg_hi:[0,1,0]
    v_pk_fma_f32 v[168:169], v[248:249], v[28:29], v[168:169] op_sel_hi:[1,0,1] neg_lo:[0,1,0] neg_hi:[0,1,0]
    v_pk_fma_f32 v[170:171], v[250:251], v[28:29], v[170:171] op_sel_hi:[1,0,1] neg_lo:[0,1,0] neg_hi:[0,1,0]
    v_pk_fma_f32 v[172:173], v[252:253], v[28:29], v[172:173] op_sel_hi:[1,0,1] neg_lo:[0,1,0] neg_hi:[0,1,0]
    v_pk_fma_f32 v[174:175], v[254:255], v[28:29], v[174:175] op_sel_hi:[1,0,1] neg_lo:[0,1,0] neg_hi:[0,1,0]
    v_pk_mul_f32 v[76:77], v[160:161], v[52:53] op_sel_hi:[1,0]
    v_pk_mul_f32 v[78:79], v[162:163], v[52:53] op_sel_hi:[1,0]
    v_pk_mul_f32 v[80:81], v[164:165], v[52:53] op_sel_hi:[1,0]
    v_pk_mul_f32 v[82:83], v[166:167], v[52:53] op_sel_hi:[1,0]
    v_exp_f32 v76, v76
    v_exp_f32 v77, v77
    v_exp_f32 v78, v78
    v_exp_f32 v79, v79
    v_exp_f32 v80, v80
    v_exp_f32 v81, v81
    v_exp_f32 v82, v82
    v_exp_f32 v83, v83
    v_pk_mul_f32 v[160:161], v[160:161], v[168:169]
    v_pk_mul_f32 v[162:163], v[162:163], v[170:171]
    v_pk_mul_f32 v[164:165], v[164:165], v[172:173]
    v_pk_mul_f32 v[166:167], v[166:167], v[174:175]
    v_pk_fma_f32 v[76:77], v[76:77], v[52:53], v[52:53] op_sel:[0,1,1] op_sel_hi:[1,1,1]
    v_pk_fma_f32 v[78:79], v[78:79], v[52:53], v[52:53] op_sel:[0,1,1] op_sel_hi:[1,1,1]
    v_pk_fma_f32 v[80:81], v[80:81], v[52:53], v[52:53] op_sel:[0,1,1] op_sel_hi:[1,1,1]
    v_pk_fma_f32 v[82:83], v[82:83], v[52:53], v[52:53] op_sel:[0,1,1] op_sel_hi:[1,1,1]
    v_rcp_f32 v76, v76
    v_rcp_f32 v77, v77
    v_rcp_f32 v78, v78
    v_rcp_f32 v79, v79
    v_rcp_f32 v80, v80
    v_rcp_f32 v81, v81
    v_rcp_f32 v82, v82
    v_rcp_f32 v83, v83
    v_pk_mul_f32 v[160:161], v[160:161], v[76:77]
    v_pk_mul_f32 v[162:163], v[162:163], v[78:79]
    v_pk_mul_f32 v[164:165], v[164:165], v[80:81]
    v_pk_mul_f32 v[166:167], v[166:167], v[82:83]
    v_cvt_pk_bf16_f32 v168, v160, v161
    v_cvt_pk_bf16_f32 v169, v162, v163
    v_cvt_pk_bf16_f32 v170, v164, v165
    v_cvt_pk_bf16_f32 v171, v166, v167
    buffer_store_dwordx2 v[168:169], v88, s[36:39], s51 offen offset:0
    buffer_store_dwordx2 v[170:171], v88, s[36:39], s51 offen offset:1024
    v_pk_fma_f32 v[176:177], v[240:241], v[30:31], v[176:177] op_sel_hi:[1,0,1] neg_lo:[0,1,0] neg_hi:[0,1,0]
    v_pk_fma_f32 v[178:179], v[242:243], v[30:31], v[178:179] op_sel_hi:[1,0,1] neg_lo:[0,1,0] neg_hi:[0,1,0]
    v_pk_fma_f32 v[180:181], v[244:245], v[30:31], v[180:181] op_sel_hi:[1,0,1] neg_lo:[0,1,0] neg_hi:[0,1,0]
    v_pk_fma_f32 v[182:183], v[246:247], v[30:31], v[182:183] op_sel_hi:[1,0,1] neg_lo:[0,1,0] neg_hi:[0,1,0]
    v_pk_fma_f32 v[184:185], v[248:249], v[30:31], v[184:185] op_sel_hi:[1,0,1] neg_lo:[0,1,0] neg_hi:[0,1,0]
    v_pk_fma_f32 v[186:187], v[250:251], v[30:31], v[186:187] op_sel_hi:[1,0,1] neg_lo:[0,1,0] neg_hi:[0,1,0]
    v_pk_fma_f32 v[188:189], v[252:253], v[30:31], v[188:189] op_sel_hi:[1,0,1] neg_lo:[0,1,0] neg_hi:[0,1,0]
    v_pk_fma_f32 v[190:191], v[254:255], v[30:31], v[190:191] op_sel_hi:[1,0,1] neg_lo:[0,1,0] neg_hi:[0,1,0]
    v_pk_mul_f32 v[76:77], v[176:177], v[54:55] op_sel_hi:[1,0]
    v_pk_mul_f32 v[78:79], v[178:179], v[54:55] op_sel_hi:[1,0]
    v_pk_mul_f32 v[80:81], v[180:181], v[54:55] op_sel_hi:[1,0]
    v_pk_mul_f32 v[82:83], v[182:183], v[54:55] op_sel_hi:[1,0]
    v_exp_f32 v76, v76
    v_exp_f32 v77, v77
    v_exp_f32 v78, v78
    v_exp_f32 v79, v79
    v_exp_f32 v80, v80
    v_exp_f32 v81, v81
    v_exp_f32 v82, v82
    v_exp_f32 v83, v83
    v_pk_mul_f32 v[176:177], v[176:177], v[184:185]
    v_pk_mul_f32 v[178:179], v[178:179], v[186:187]
    v_pk_mul_f32 v[180:181], v[180:181], v[188:189]
    v_pk_mul_f32 v[182:183], v[182:183], v[190:191]
    v_pk_fma_f32 v[76:77], v[76:77], v[54:55], v[54:55] op_sel:[0,1,1] op_sel_hi:[1,1,1]
    v_pk_fma_f32 v[78:79], v[78:79], v[54:55], v[54:55] op_sel:[0,1,1] op_sel_hi:[1,1,1]
    v_pk_fma_f32 v[80:81], v[80:81], v[54:55], v[54:55] op_sel:[0,1,1] op_sel_hi:[1,1,1]
    v_pk_fma_f32 v[82:83], v[82:83], v[54:55], v[54:55] op_sel:[0,1,1] op_sel_hi:[1,1,1]
    v_rcp_f32 v76, v76
    v_rcp_f32 v77, v77
    v_rcp_f32 v78, v78
    v_rcp_f32 v79, v79
    v_rcp_f32 v80, v80
    v_rcp_f32 v81, v81
    v_rcp_f32 v82, v82
    v_rcp_f32 v83, v83
    v_pk_mul_f32 v[176:177], v[176:177], v[76:77]
    v_pk_mul_f32 v[178:179], v[178:179], v[78:79]
    v_pk_mul_f32 v[180:181], v[180:181], v[80:81]
    v_pk_mul_f32 v[182:183], v[182:183], v[82:83]
    v_cvt_pk_bf16_f32 v184, v176, v177
    v_cvt_pk_bf16_f32 v185, v178, v179
    v_cvt_pk_bf16_f32 v186, v180, v181
    v_cvt_pk_bf16_f32 v187, v182, v183
    buffer_store_dwordx2 v[184:185], v89, s[36:39], s51 offen offset:0
    buffer_store_dwordx2 v[186:187], v89, s[36:39], s51 offen offset:1024
    v_pk_fma_f32 v[192:193], v[240:241], v[32:33], v[192:193] op_sel_hi:[1,0,1] neg_lo:[0,1,0] neg_hi:[0,1,0]
    v_pk_fma_f32 v[194:195], v[242:243], v[32:33], v[194:195] op_sel_hi:[1,0,1] neg_lo:[0,1,0] neg_hi:[0,1,0]
    v_pk_fma_f32 v[196:197], v[244:245], v[32:33], v[196:197] op_sel_hi:[1,0,1] neg_lo:[0,1,0] neg_hi:[0,1,0]
    v_pk_fma_f32 v[198:199], v[246:247], v[32:33], v[198:199] op_sel_hi:[1,0,1] neg_lo:[0,1,0] neg_hi:[0,1,0]
    v_pk_fma_f32 v[200:201], v[248:249], v[32:33], v[200:201] op_sel_hi:[1,0,1] neg_lo:[0,1,0] neg_hi:[0,1,0]
    v_pk_fma_f32 v[202:203], v[250:251], v[32:33], v[202:203] op_sel_hi:[1,0,1] neg_lo:[0,1,0] neg_hi:[0,1,0]
    v_pk_fma_f32 v[204:205], v[252:253], v[32:33], v[204:205] op_sel_hi:[1,0,1] neg_lo:[0,1,0] neg_hi:[0,1,0]
    v_pk_fma_f32 v[206:207], v[254:255], v[32:33], v[206:207] op_sel_hi:[1,0,1] neg_lo:[0,1,0] neg_hi:[0,1,0]
    v_pk_mul_f32 v[76:77], v[192:193], v[56:57] op_sel_hi:[1,0]
    v_pk_mul_f32 v[78:79], v[194:195], v[56:57] op_sel_hi:[1,0]
    v_pk_mul_f32 v[80:81], v[196:197], v[56:57] op_sel_hi:[1,0]
    v_pk_mul_f32 v[82:83], v[198:199], v[56:57] op_sel_hi:[1,0]
    v_exp_f32 v76, v76
    v_exp_f32 v77, v77
    v_exp_f32 v78, v78
    v_exp_f32 v79, v79
    v_exp_f32 v80, v80
    v_exp_f32 v81, v81
    v_exp_f32 v82, v82
    v_exp_f32 v83, v83
    v_pk_mul_f32 v[192:193], v[192:193], v[200:201]
    v_pk_mul_f32 v[194:195], v[194:195], v[202:203]
    v_pk_mul_f32 v[196:197], v[196:197], v[204:205]
    v_pk_mul_f32 v[198:199], v[198:199], v[206:207]
    v_pk_fma_f32 v[76:77], v[76:77], v[56:57], v[56:57] op_sel:[0,1,1] op_sel_hi:[1,1,1]
    v_pk_fma_f32 v[78:79], v[78:79], v[56:57], v[56:57] op_sel:[0,1,1] op_sel_hi:[1,1,1]
    v_pk_fma_f32 v[80:81], v[80:81], v[56:57], v[56:57] op_sel:[0,1,1] op_sel_hi:[1,1,1]
    v_pk_fma_f32 v[82:83], v[82:83], v[56:57], v[56:57] op_sel:[0,1,1] op_sel_hi:[1,1,1]
    v_rcp_f32 v76, v76
    v_rcp_f32 v77, v77
    v_rcp_f32 v78, v78
    v_rcp_f32 v79, v79
    v_rcp_f32 v80, v80
    v_rcp_f32 v81, v81
    v_rcp_f32 v82, v82
    v_rcp_f32 v83, v83
    v_pk_mul_f32 v[192:193], v[192:193], v[76:77]
    v_pk_mul_f32 v[194:195], v[194:195], v[78:79]
    v_pk_mul_f32 v[196:197], v[196:197], v[80:81]
    v_pk_mul_f32 v[198:199], v[198:199], v[82:83]
    v_cvt_pk_bf16_f32 v200, v192, v193
    v_cvt_pk_bf16_f32 v201, v194, v195
    v_cvt_pk_bf16_f32 v202, v196, v197
    v_cvt_pk_bf16_f32 v203, v198, v199
    buffer_store_dwordx2 v[200:201], v90, s[36:39], s51 offen offset:0
    buffer_store_dwordx2 v[202:203], v90, s[36:39], s51 offen offset:1024
    v_pk_fma_f32 v[208:209], v[240:241], v[34:35], v[208:209] op_sel_hi:[1,0,1] neg_lo:[0,1,0] neg_hi:[0,1,0]
    v_pk_fma_f32 v[210:211], v[242:243], v[34:35], v[210:211] op_sel_hi:[1,0,1] neg_lo:[0,1,0] neg_hi:[0,1,0]
    v_pk_fma_f32 v[212:213], v[244:245], v[34:35], v[212:213] op_sel_hi:[1,0,1] neg_lo:[0,1,0] neg_hi:[0,1,0]
    v_pk_fma_f32 v[214:215], v[246:247], v[34:35], v[214:215] op_sel_hi:[1,0,1] neg_lo:[0,1,0] neg_hi:[0,1,0]
    v_pk_fma_f32 v[216:217], v[248:249], v[34:35], v[216:217] op_sel_hi:[1,0,1] neg_lo:[0,1,0] neg_hi:[0,1,0]
    v_pk_fma_f32 v[218:219], v[250:251], v[34:35], v[218:219] op_sel_hi:[1,0,1] neg_lo:[0,1,0] neg_hi:[0,1,0]
    v_pk_fma_f32 v[220:221], v[252:253], v[34:35], v[220:221] op_sel_hi:[1,0,1] neg_lo:[0,1,0] neg_hi:[0,1,0]
    v_pk_fma_f32 v[222:223], v[254:255], v[34:35], v[222:223] op_sel_hi:[1,0,1] neg_lo:[0,1,0] neg_hi:[0,1,0]
    v_pk_mul_f32 v[76:77], v[208:209], v[58:59] op_sel_hi:[1,0]
    v_pk_mul_f32 v[78:79], v[210:211], v[58:59] op_sel_hi:[1,0]
    v_pk_mul_f32 v[80:81], v[212:213], v[58:59] op_sel_hi:[1,0]
    v_pk_mul_f32 v[82:83], v[214:215], v[58:59] op_sel_hi:[1,0]
    v_exp_f32 v76, v76
    v_exp_f32 v77, v77
    v_exp_f32 v78, v78
    v_exp_f32 v79, v79
    v_exp_f32 v80, v80
    v_exp_f32 v81, v81
    v_exp_f32 v82, v82
    v_exp_f32 v83, v83
    v_pk_mul_f32 v[208:209], v[208:209], v[216:217]
    v_pk_mul_f32 v[210:211], v[210:211], v[218:219]
    v_pk_mul_f32 v[212:213], v[212:213], v[220:221]
    v_pk_mul_f32 v[214:215], v[214:215], v[222:223]
    v_pk_fma_f32 v[76:77], v[76:77], v[58:59], v[58:59] op_sel:[0,1,1] op_sel_hi:[1,1,1]
    v_pk_fma_f32 v[78:79], v[78:79], v[58:59], v[58:59] op_sel:[0,1,1] op_sel_hi:[1,1,1]
    v_pk_fma_f32 v[80:81], v[80:81], v[58:59], v[58:59] op_sel:[0,1,1] op_sel_hi:[1,1,1]
    v_pk_fma_f32 v[82:83], v[82:83], v[58:59], v[58:59] op_sel:[0,1,1] op_sel_hi:[1,1,1]
    v_rcp_f32 v76, v76
    v_rcp_f32 v77, v77
    v_rcp_f32 v78, v78
    v_rcp_f32 v79, v79
    v_rcp_f32 v80, v80
    v_rcp_f32 v81, v81
    v_rcp_f32 v82, v82
    v_rcp_f32 v83, v83
    v_pk_mul_f32 v[208:209], v[208:209], v[76:77]
    v_pk_mul_f32 v[210:211], v[210:211], v[78:79]
    v_pk_mul_f32 v[212:213], v[212:213], v[80:81]
    v_pk_mul_f32 v[214:215], v[214:215], v[82:83]
    v_cvt_pk_bf16_f32 v216, v208, v209
    v_cvt_pk_bf16_f32 v217, v210, v211
    v_cvt_pk_bf16_f32 v218, v212, v213
    v_cvt_pk_bf16_f32 v219, v214, v215
    buffer_store_dwordx2 v[216:217], v91, s[36:39], s51 offen offset:0
    buffer_store_dwordx2 v[218:219], v91, s[36:39], s51 offen offset:1024
    v_pk_fma_f32 v[224:225], v[240:241], v[36:37], v[224:225] op_sel_hi:[1,0,1] neg_lo:[0,1,0] neg_hi:[0,1,0]
    v_pk_fma_f32 v[226:227], v[242:243], v[36:37], v[226:227] op_sel_hi:[1,0,1] neg_lo:[0,1,0] neg_hi:[0,1,0]
    v_pk_fma_f32 v[228:229], v[244:245], v[36:37], v[228:229] op_sel_hi:[1,0,1] neg_lo:[0,1,0] neg_hi:[0,1,0]
    v_pk_fma_f32 v[230:231], v[246:247], v[36:37], v[230:231] op_sel_hi:[1,0,1] neg_lo:[0,1,0] neg_hi:[0,1,0]
    v_pk_fma_f32 v[232:233], v[248:249], v[36:37], v[232:233] op_sel_hi:[1,0,1] neg_lo:[0,1,0] neg_hi:[0,1,0]
    v_pk_fma_f32 v[234:235], v[250:251], v[36:37], v[234:235] op_sel_hi:[1,0,1] neg_lo:[0,1,0] neg_hi:[0,1,0]
    v_pk_fma_f32 v[236:237], v[252:253], v[36:37], v[236:237] op_sel_hi:[1,0,1] neg_lo:[0,1,0] neg_hi:[0,1,0]
    v_pk_fma_f32 v[238:239], v[254:255], v[36:37], v[238:239] op_sel_hi:[1,0,1] neg_lo:[0,1,0] neg_hi:[0,1,0]
    v_pk_mul_f32 v[76:77], v[224:225], v[60:61] op_sel_hi:[1,0]
    v_pk_mul_f32 v[78:79], v[226:227], v[60:61] op_sel_hi:[1,0]
    v_pk_mul_f32 v[80:81], v[228:229], v[60:61] op_sel_hi:[1,0]
    v_pk_mul_f32 v[82:83], v[230:231], v[60:61] op_sel_hi:[1,0]
    v_exp_f32 v76, v76
    v_exp_f32 v77, v77
    v_exp_f32 v78, v78
    v_exp_f32 v79, v79
    v_exp_f32 v80, v80
    v_exp_f32 v81, v81
    v_exp_f32 v82, v82
    v_exp_f32 v83, v83
    v_pk_mul_f32 v[224:225], v[224:225], v[232:233]
    v_pk_mul_f32 v[226:227], v[226:227], v[234:235]
    v_pk_mul_f32 v[228:229], v[228:229], v[236:237]
    v_pk_mul_f32 v[230:231], v[230:231], v[238:239]
    v_pk_fma_f32 v[76:77], v[76:77], v[60:61], v[60:61] op_sel:[0,1,1] op_sel_hi:[1,1,1]
    v_pk_fma_f32 v[78:79], v[78:79], v[60:61], v[60:61] op_sel:[0,1,1] op_sel_hi:[1,1,1]
    v_pk_fma_f32 v[80:81], v[80:81], v[60:61], v[60:61] op_sel:[0,1,1] op_sel_hi:[1,1,1]
    v_pk_fma_f32 v[82:83], v[82:83], v[60:61], v[60:61] op_sel:[0,1,1] op_sel_hi:[1,1,1]
    v_rcp_f32 v76, v76
    v_rcp_f32 v77, v77
    v_rcp_f32 v78, v78
    v_rcp_f32 v79, v79
    v_rcp_f32 v80, v80
    v_rcp_f32 v81, v81
    v_rcp_f32 v82, v82
    v_rcp_f32 v83, v83
    v_pk_mul_f32 v[224:225], v[224:225], v[76:77]
    v_pk_mul_f32 v[226:227], v[226:227], v[78:79]
    v_pk_mul_f32 v[228:229], v[228:229], v[80:81]
    v_pk_mul_f32 v[230:231], v[230:231], v[82:83]
    v_cvt_pk_bf16_f32 v232, v224, v225
    v_cvt_pk_bf16_f32 v233, v226, v227
    v_cvt_pk_bf16_f32 v234, v228, v229
    v_cvt_pk_bf16_f32 v235, v230, v231
    s_mov_b64 exec, s[58:59]
    buffer_store_dwordx2 v[232:233], v92, s[36:39], s51 offen offset:0
    buffer_store_dwordx2 v[234:235], v92, s[36:39], s51 offen offset:1024
    s_endpgm
proj_kernel_loader:
    s_sub_u32 s46, s46, 4
    v_lshrrev_b32 v4, 4, v0
    s_and_b32 s3, s46, 1
    s_lshl_b32 s3, s3, 2
    v_add_u32 v5, s3, v4
    v_and_b32 v6, 7, v0
    v_xor_b32 v5, v5, v6
    v_lshlrev_b32 v5, 4, v5
    v_lshrrev_b32 v6, 3, v0
    v_lshl_add_u32 v1, v6, 10, v5
    v_lshlrev_b32 v5, 1, v4
    v_and_b32 v6, 15, v0
    v_xor_b32 v5, v5, v6
    v_lshlrev_b32 v5, 4, v5
    v_mul_lo_u32 v6, v4, s47
    v_add_u32 v2, v5, v6
    v_xor_b32 v3, 128, v5
    v_add_u32 v3, v3, v6
    s_mul_i32 s48, s44, 146432
    s_lshl_b32 s3, s46, 13
    s_add_u32 s48, s48, s3
    s_lshl_b32 s49, s47, 4
    s_mul_i32 s49, s49, s46
    s_lshl_b32 s50, s47, 2
    s_lshl_b32 s51, s47, 6
    s_lshl_b32 s52, s46, 10
    s_lshl_b32 s53, s46, 12
    s_add_u32 s53, s53, 18432
    v_lshlrev_b32 v7, 4, v0
    v_add_u32 v7, s52, v7
    s_add_u32 s54, s2, 0
    s_and_b32 s54, s54, 7
    s_mul_i32 s54, s54, 1
    s_and_b32 s54, s54, 7
    s_mul_i32 s3, s54, s51
    s_add_u32 s65, s49, s3
    s_lshl_b32 s54, s54, 7
    s_add_u32 s66, s48, s54
    v_add_u32 v8, 51200, v7
    v_add_u32 v9, 102400, v7
    s_mov_b32 s60, -1
    s_cmp_eq_u32 s46, 1
    s_cselect_b32 s61, 0x00ffffff, -1
    s_setprio 2
    s_waitcnt lgkmcnt(0)
    s_mov_b32 s36, s22
    s_and_b32 s37, s23, 0xffff
    s_mov_b32 s38, 25165824
    s_mov_b32 s39, 0x20000
    s_mov_b32 s92, s20
    s_and_b32 s93, s21, 0xffff
    s_mov_b32 s94, 256
    s_mov_b32 s95, 0x20000
    s_mov_b32 s24, s4
    s_and_b32 s25, s5, 0xffff
    s_mov_b32 s26, 2097152
    s_mov_b32 s27, 0x20000
    s_cmp_ge_u32 s45, 6
    s_cbranch_scc1 proj_kernel_wffnl
    s_lshl_b32 s3, s45, 9
    s_add_u32 s28, s6, s3
    s_addc_u32 s29, s7, 0
    s_sub_u32 s30, 1572864, s3
    s_add_u32 s32, s28, 256
    s_addc_u32 s33, s29, 0
    s_sub_u32 s34, s30, 256
    s_branch proj_kernel_wdonel
proj_kernel_wffnl:
    s_sub_u32 s3, s45, 6
    s_lshl_b32 s3, s3, 8
    s_add_u32 s28, s12, s3
    s_addc_u32 s29, s13, 0
    s_sub_u32 s30, 1409024, s3
    s_add_u32 s32, s14, s3
    s_addc_u32 s33, s15, 0
    s_mov_b32 s34, s30
proj_kernel_wdonel:
    s_and_b32 s29, s29, 0xffff
    s_and_b32 s33, s33, 0xffff
    s_mov_b32 s31, 0x20000
    s_mov_b32 s35, 0x20000
    s_cmp_ge_u32 s46, 2
    s_cbranch_scc1 proj_kernel_sk0
    s_add_u32 m0, s52, 16384
    s_add_u32 s3, s66, 131072
    s_mov_b64 exec, s[60:61]
    buffer_load_dwordx4 v1, s[24:27], s3 offen lds
    s_mov_b64 exec, -1
proj_kernel_sk0:
    s_add_u32 m0, s52, 0
    s_add_u32 s3, s66, 0
    buffer_load_dwordx4 v1, s[24:27], s3 offen lds
    s_add_u32 m0, s52, 4096
    s_add_u32 s3, s66, 32768
    buffer_load_dwordx4 v1, s[24:27], s3 offen lds
    s_add_u32 m0, s52, 8192
    s_add_u32 s3, s66, 65536
    buffer_load_dwordx4 v1, s[24:27], s3 offen lds
    s_add_u32 m0, s52, 12288
    s_add_u32 s3, s66, 98304
    buffer_load_dwordx4 v1, s[24:27], s3 offen lds
    s_mov_b32 s3, s65
    s_add_u32 m0, s53, 0
    s_nop 0
    buffer_load_dwordx4 v2, s[28:31], s3 offen lds
    s_add_u32 m0, s53, 16384
    s_nop 0
    buffer_load_dwordx4 v2, s[32:35], s3 offen lds
    s_add_u32 s3, s3, s50
    s_add_u32 m0, s53, 1024
    s_nop 0
    buffer_load_dwordx4 v2, s[28:31], s3 offen lds
    s_add_u32 m0, s53, 17408
    s_nop 0
    buffer_load_dwordx4 v2, s[32:35], s3 offen lds
    s_add_u32 s3, s3, s50
    s_add_u32 m0, s53, 2048
    s_nop 0
    buffer_load_dwordx4 v3, s[28:31], s3 offen lds
    s_add_u32 m0, s53, 18432
    s_nop 0
    buffer_load_dwordx4 v3, s[32:35], s3 offen lds
    s_add_u32 s3, s3, s50
    s_add_u32 m0, s53, 3072
    s_nop 0
    buffer_load_dwordx4 v3, s[28:31], s3 offen lds
    s_add_u32 m0, s53, 19456
    s_nop 0
    buffer_load_dwordx4 v3, s[32:35], s3 offen lds
    s_add_u32 s65, s65, s51
    s_add_u32 s54, s54, 128
    s_and_b32 s54, s54, 1023
    s_cselect_b32 s65, s65, s49
    s_add_u32 s66, s48, s54
    s_cmp_ge_u32 s46, 2
    s_cbranch_scc1 proj_kernel_sk1
    s_add_u32 m0, s52, 67584
    s_add_u32 s3, s66, 131072
    s_mov_b64 exec, s[60:61]
    buffer_load_dwordx4 v1, s[24:27], s3 offen lds
    s_mov_b64 exec, -1
proj_kernel_sk1:
    s_add_u32 m0, s52, 51200
    s_add_u32 s3, s66, 0
    buffer_load_dwordx4 v1, s[24:27], s3 offen lds
    s_add_u32 m0, s52, 55296
    s_add_u32 s3, s66, 32768
    buffer_load_dwordx4 v1, s[24:27], s3 offen lds
    s_add_u32 m0, s52, 59392
    s_add_u32 s3, s66, 65536
    buffer_load_dwordx4 v1, s[24:27], s3 offen lds
    s_add_u32 m0, s52, 63488
    s_add_u32 s3, s66, 98304
    buffer_load_dwordx4 v1, s[24:27], s3 offen lds
    s_mov_b32 s3, s65
    s_add_u32 m0, s53, 51200
    s_nop 0
    buffer_load_dwordx4 v2, s[28:31], s3 offen lds
    s_add_u32 m0, s53, 67584
    s_nop 0
    buffer_load_dwordx4 v2, s[32:35], s3 offen lds
    s_add_u32 s3, s3, s50
    s_add_u32 m0, s53, 52224
    s_nop 0
    buffer_load_dwordx4 v2, s[28:31], s3 offen lds
    s_add_u32 m0, s53, 68608
    s_nop 0
    buffer_load_dwordx4 v2, s[32:35], s3 offen lds
    s_add_u32 s3, s3, s50
    s_add_u32 m0, s53, 53248
    s_nop 0
    buffer_load_dwordx4 v3, s[28:31], s3 offen lds
    s_add_u32 m0, s53, 69632
    s_nop 0
    buffer_load_dwordx4 v3, s[32:35], s3 offen lds
    s_add_u32 s3, s3, s50
    s_add_u32 m0, s53, 54272
    s_nop 0
    buffer_load_dwordx4 v3, s[28:31], s3 offen lds
    s_add_u32 m0, s53, 70656
    s_nop 0
    buffer_load_dwordx4 v3, s[32:35], s3 offen lds
    s_add_u32 s65, s65, s51
    s_add_u32 s54, s54, 128
    s_and_b32 s54, s54, 1023
    s_cselect_b32 s65, s65, s49
    s_add_u32 s66, s48, s54
    s_cmp_lg_u32 s46, 1
    s_cbranch_scc1 proj_kernel_noone
    v_mov_b32 v12, 0x3f803f80
    v_mov_b32 v13, 0x3f803f80
    v_mov_b32 v14, 0x3f803f80
    v_mov_b32 v15, 0x3f803f80
    s_mov_b32 exec_lo, 0
    s_mov_b32 exec_hi, 0xff000000
    ds_write_b128 v7, v[12:15] offset:16384
    ds_write_b128 v8, v[12:15] offset:16384
    ds_write_b128 v9, v[12:15] offset:16384
    s_mov_b64 exec, -1
    s_waitcnt lgkmcnt(0)
proj_kernel_noone:
    v_add_u32 v20, 0, v0
    v_min_u32 v20, 143, v20
    v_mul_u32_u24 v21, 21846, v20
    v_lshrrev_b32 v21, 16, v21
    v_mul_u32_u24 v22, 3, v21
    v_sub_u32 v22, v20, v22
    v_lshlrev_b32 v22, 5, v22
    v_lshl_add_u32 v24, v21, 7, v22
    v_lshlrev_b32 v28, 3, v20
    v_add_u32 v28, 153600, v28
    v_add_u32 v20, 64, v0
    v_min_u32 v20, 143, v20
    v_mul_u32_u24 v21, 21846, v20
    v_lshrrev_b32 v21, 16, v21
    v_mul_u32_u24 v22, 3, v21
    v_sub_u32 v22, v20, v22
    v_lshlrev_b32 v22, 5, v22
    v_lshl_add_u32 v25, v21, 7, v22
    v_lshlrev_b32 v29, 3, v20
    v_add_u32 v29, 153600, v29
    v_add_u32 v20, 128, v0
    v_min_u32 v20, 143, v20
    v_mul_u32_u24 v21, 21846, v20
    v_lshrrev_b32 v21, 16, v21
    v_mul_u32_u24 v22, 3, v21
    v_sub_u32 v22, v20, v22
    v_lshlrev_b32 v22, 5, v22
    v_lshl_add_u32 v26, v21, 7, v22
    v_lshlrev_b32 v30, 3, v20
    v_add_u32 v30, 153600, v30
    v_mov_b32 v13, 0
    s_waitcnt vmcnt(12)
    s_barrier
    s_cmp_ge_u32 s46, 2
    s_cbranch_scc1 proj_kernel_sk2
    s_add_u32 m0, s52, 118784
    s_add_u32 s3, s66, 131072
    s_mov_b64 exec, s[60:61]
    buffer_load_dwordx4 v1, s[24:27], s3 offen lds
    s_mov_b64 exec, -1
proj_kernel_sk2:
    s_add_u32 m0, s52, 102400
    s_add_u32 s3, s66, 0
    buffer_load_dwordx4 v1, s[24:27], s3 offen lds
    s_add_u32 m0, s52, 106496
    s_add_u32 s3, s66, 32768
    buffer_load_dwordx4 v1, s[24:27], s3 offen lds
    s_add_u32 m0, s52, 110592
    s_add_u32 s3, s66, 65536
    buffer_load_dwordx4 v1, s[24:27], s3 offen lds
    s_add_u32 m0, s52, 114688
    s_add_u32 s3, s66, 98304
    buffer_load_dwordx4 v1, s[24:27], s3 offen lds
    s_mov_b32 s3, s65
    s_add_u32 m0, s53, 102400
    s_nop 0
    buffer_load_dwordx4 v2, s[28:31], s3 offen lds
    s_add_u32 m0, s53, 118784
    s_nop 0
    buffer_load_dwordx4 v2, s[32:35], s3 offen lds
    s_add_u32 s3, s3, s50
    s_add_u32 m0, s53, 103424
    s_nop 0
    buffer_load_dwordx4 v2, s[28:31], s3 offen lds
    s_add_u32 m0, s53, 119808
    s_nop 0
    buffer_load_dwordx4 v2, s[32:35], s3 offen lds
    s_add_u32 s3, s3, s50
    s_add_u32 m0, s53, 104448
    s_nop 0
    buffer_load_dwordx4 v3, s[28:31], s3 offen lds
    s_add_u32 m0, s53, 120832
    s_nop 0
    buffer_load_dwordx4 v3, s[32:35], s3 offen lds
    s_add_u32 s3, s3, s50
    s_add_u32 m0, s53, 105472
    s_nop 0
    buffer_load_dwordx4 v3, s[28:31], s3 offen lds
    s_add_u32 m0, s53, 121856
    s_nop 0
    buffer_load_dwordx4 v3, s[32:35], s3 offen lds
    s_add_u32 s65, s65, s51
    s_add_u32 s54, s54, 128
    s_and_b32 s54, s54, 1023
    s_cselect_b32 s65, s65, s49
    s_add_u32 s66, s48, s54
    s_waitcnt vmcnt(12)
    s_barrier
    s_cmp_ge_u32 s46, 2
    s_cbranch_scc1 proj_kernel_sk3
    s_add_u32 m0, s52, 16384
    s_add_u32 s3, s66, 131072
    s_mov_b64 exec, s[60:61]
    buffer_load_dwordx4 v1, s[24:27], s3 offen lds
    s_mov_b64 exec, -1
proj_kernel_sk3:
    s_add_u32 m0, s52, 0
    s_add_u32 s3, s66, 0
    buffer_load_dwordx4 v1, s[24:27], s3 offen lds
    s_add_u32 m0, s52, 4096
    s_add_u32 s3, s66, 32768
    buffer_load_dwordx4 v1, s[24:27], s3 offen lds
    s_add_u32 m0, s52, 8192
    s_add_u32 s3, s66, 65536
    buffer_load_dwordx4 v1, s[24:27], s3 offen lds
    s_add_u32 m0, s52, 12288
    s_add_u32 s3, s66, 98304
    buffer_load_dwordx4 v1, s[24:27], s3 offen lds
    s_mov_b32 s3, s65
    s_add_u32 m0, s53, 0
    s_nop 0
    buffer_load_dwordx4 v2, s[28:31], s3 offen lds
    s_add_u32 m0, s53, 16384
    s_nop 0
    buffer_load_dwordx4 v2, s[32:35], s3 offen lds
    s_add_u32 s3, s3, s50
    s_add_u32 m0, s53, 1024
    s_nop 0
    buffer_load_dwordx4 v2, s[28:31], s3 offen lds
    s_add_u32 m0, s53, 17408
    s_nop 0
    buffer_load_dwordx4 v2, s[32:35], s3 offen lds
    s_add_u32 s3, s3, s50
    s_add_u32 m0, s53, 2048
    s_nop 0
    buffer_load_dwordx4 v3, s[28:31], s3 offen lds
    s_add_u32 m0, s53, 18432
    s_nop 0
    buffer_load_dwordx4 v3, s[32:35], s3 offen lds
    s_add_u32 s3, s3, s50
    s_add_u32 m0, s53, 3072
    s_nop 0
    buffer_load_dwordx4 v3, s[28:31], s3 offen lds
    s_add_u32 m0, s53, 19456
    s_nop 0
    buffer_load_dwordx4 v3, s[32:35], s3 offen lds
    s_add_u32 s65, s65, s51
    s_add_u32 s54, s54, 128
    s_and_b32 s54, s54, 1023
    s_cselect_b32 s65, s65, s49
    s_add_u32 s66, s48, s54
    s_waitcnt vmcnt(12)
    s_barrier
    s_cmp_ge_u32 s46, 2
    s_cbranch_scc1 proj_kernel_sk4
    s_add_u32 m0, s52, 67584
    s_add_u32 s3, s66, 131072
    s_mov_b64 exec, s[60:61]
    buffer_load_dwordx4 v1, s[24:27], s3 offen lds
    s_mov_b64 exec, -1
proj_kernel_sk4:
    s_add_u32 m0, s52, 51200
    s_add_u32 s3, s66, 0
    buffer_load_dwordx4 v1, s[24:27], s3 offen lds
    s_add_u32 m0, s52, 55296
    s_add_u32 s3, s66, 32768
    buffer_load_dwordx4 v1, s[24:27], s3 offen lds
    s_add_u32 m0, s52, 59392
    s_add_u32 s3, s66, 65536
    buffer_load_dwordx4 v1, s[24:27], s3 offen lds
    s_add_u32 m0, s52, 63488
    s_add_u32 s3, s66, 98304
    buffer_load_dwordx4 v1, s[24:27], s3 offen lds
    s_mov_b32 s3, s65
    s_add_u32 m0, s53, 51200
    s_nop 0
    buffer_load_dwordx4 v2, s[28:31], s3 offen lds
    s_add_u32 m0, s53, 67584
    s_nop 0
    buffer_load_dwordx4 v2, s[32:35], s3 offen lds
    s_add_u32 s3, s3, s50
    s_add_u32 m0, s53, 52224
    s_nop 0
    buffer_load_dwordx4 v2, s[28:31], s3 offen lds
    s_add_u32 m0, s53, 68608
    s_nop 0
    buffer_load_dwordx4 v2, s[32:35], s3 offen lds
    s_add_u32 s3, s3, s50
    s_add_u32 m0, s53, 53248
    s_nop 0
    buffer_load_dwordx4 v3, s[28:31], s3 offen lds
    s_add_u32 m0, s53, 69632
    s_nop 0
    buffer_load_dwordx4 v3, s[32:35], s3 offen lds
    s_add_u32 s3, s3, s50
    s_add_u32 m0, s53, 54272
    s_nop 0
    buffer_load_dwordx4 v3, s[28:31], s3 offen lds
    s_add_u32 m0, s53, 70656
    s_nop 0
    buffer_load_dwordx4 v3, s[32:35], s3 offen lds
    s_add_u32 s65, s65, s51
    s_add_u32 s54, s54, 128
    s_and_b32 s54, s54, 1023
    s_cselect_b32 s65, s65, s49
    s_add_u32 s66, s48, s54
    s_cmp_lg_u32 s46, 3
    s_cbranch_scc1 proj_kernel_nosig
    s_cmp_eq_u32 s45, 16
    s_cbranch_scc1 proj_kernel_nosig
    s_lshl_b32 s3, s44, 2
    v_mov_b32 v12, 1
    v_mov_b32 v13, 0
    s_mov_b64 exec, 1
    buffer_atomic_add v12, v13, s[92:95], s3 offen sc1
    s_mov_b64 exec, -1
proj_kernel_nosig:
    s_waitcnt vmcnt(12)
    s_barrier
    s_cmp_ge_u32 s46, 2
    s_cbranch_scc1 proj_kernel_sk5
    s_add_u32 m0, s52, 118784
    s_add_u32 s3, s66, 131072
    s_mov_b64 exec, s[60:61]
    buffer_load_dwordx4 v1, s[24:27], s3 offen lds
    s_mov_b64 exec, -1
proj_kernel_sk5:
    s_add_u32 m0, s52, 102400
    s_add_u32 s3, s66, 0
    buffer_load_dwordx4 v1, s[24:27], s3 offen lds
    s_add_u32 m0, s52, 106496
    s_add_u32 s3, s66, 32768
    buffer_load_dwordx4 v1, s[24:27], s3 offen lds
    s_add_u32 m0, s52, 110592
    s_add_u32 s3, s66, 65536
    buffer_load_dwordx4 v1, s[24:27], s3 offen lds
    s_add_u32 m0, s52, 114688
    s_add_u32 s3, s66, 98304
    buffer_load_dwordx4 v1, s[24:27], s3 offen lds
    s_mov_b32 s3, s65
    s_add_u32 m0, s53, 102400
    s_nop 0
    buffer_load_dwordx4 v2, s[28:31], s3 offen lds
    s_add_u32 m0, s53, 118784
    s_nop 0
    buffer_load_dwordx4 v2, s[32:35], s3 offen lds
    s_add_u32 s3, s3, s50
    s_add_u32 m0, s53, 103424
    s_nop 0
    buffer_load_dwordx4 v2, s[28:31], s3 offen lds
    s_add_u32 m0, s53, 119808
    s_nop 0
    buffer_load_dwordx4 v2, s[32:35], s3 offen lds
    s_add_u32 s3, s3, s50
    s_add_u32 m0, s53, 104448
    s_nop 0
    buffer_load_dwordx4 v3, s[28:31], s3 offen lds
    s_add_u32 m0, s53, 120832
    s_nop 0
    buffer_load_dwordx4 v3, s[32:35], s3 offen lds
    s_add_u32 s3, s3, s50
    s_add_u32 m0, s53, 105472
    s_nop 0
    buffer_load_dwordx4 v3, s[28:31], s3 offen lds
    s_add_u32 m0, s53, 121856
    s_nop 0
    buffer_load_dwordx4 v3, s[32:35], s3 offen lds
    s_add_u32 s65, s65, s51
    s_add_u32 s54, s54, 128
    s_and_b32 s54, s54, 1023
    s_cselect_b32 s65, s65, s49
    s_add_u32 s66, s48, s54
    s_waitcnt vmcnt(12)
    s_barrier
    s_cmp_ge_u32 s46, 2
    s_cbranch_scc1 proj_kernel_sk6
    s_add_u32 m0, s52, 16384
    s_add_u32 s3, s66, 131072
    s_mov_b64 exec, s[60:61]
    buffer_load_dwordx4 v1, s[24:27], s3 offen lds
    s_mov_b64 exec, -1
proj_kernel_sk6:
    s_add_u32 m0, s52, 0
    s_add_u32 s3, s66, 0
    buffer_load_dwordx4 v1, s[24:27], s3 offen lds
    s_add_u32 m0, s52, 4096
    s_add_u32 s3, s66, 32768
    buffer_load_dwordx4 v1, s[24:27], s3 offen lds
    s_add_u32 m0, s52, 8192
    s_add_u32 s3, s66, 65536
    buffer_load_dwordx4 v1, s[24:27], s3 offen lds
    s_add_u32 m0, s52, 12288
    s_add_u32 s3, s66, 98304
    buffer_load_dwordx4 v1, s[24:27], s3 offen lds
    s_mov_b32 s3, s65
    s_add_u32 m0, s53, 0
    s_nop 0
    buffer_load_dwordx4 v2, s[28:31], s3 offen lds
    s_add_u32 m0, s53, 16384
    s_nop 0
    buffer_load_dwordx4 v2, s[32:35], s3 offen lds
    s_add_u32 s3, s3, s50
    s_add_u32 m0, s53, 1024
    s_nop 0
    buffer_load_dwordx4 v2, s[28:31], s3 offen lds
    s_add_u32 m0, s53, 17408
    s_nop 0
    buffer_load_dwordx4 v2, s[32:35], s3 offen lds
    s_add_u32 s3, s3, s50
    s_add_u32 m0, s53, 2048
    s_nop 0
    buffer_load_dwordx4 v3, s[28:31], s3 offen lds
    s_add_u32 m0, s53, 18432
    s_nop 0
    buffer_load_dwordx4 v3, s[32:35], s3 offen lds
    s_add_u32 s3, s3, s50
    s_add_u32 m0, s53, 3072
    s_nop 0
    buffer_load_dwordx4 v3, s[28:31], s3 offen lds
    s_add_u32 m0, s53, 19456
    s_nop 0
    buffer_load_dwordx4 v3, s[32:35], s3 offen lds
    s_add_u32 s65, s65, s51
    s_add_u32 s54, s54, 128
    s_and_b32 s54, s54, 1023
    s_cselect_b32 s65, s65, s49
    s_add_u32 s66, s48, s54
    s_waitcnt vmcnt(12)
    s_barrier
    s_cmp_ge_u32 s46, 2
    s_cbranch_scc1 proj_kernel_sk7
    s_add_u32 m0, s52, 67584
    s_add_u32 s3, s66, 131072
    s_mov_b64 exec, s[60:61]
    buffer_load_dwordx4 v1, s[24:27], s3 offen lds
    s_mov_b64 exec, -1
proj_kernel_sk7:
    s_add_u32 m0, s52, 51200
    s_add_u32 s3, s66, 0
    buffer_load_dwordx4 v1, s[24:27], s3 offen lds
    s_add_u32 m0, s52, 55296
    s_add_u32 s3, s66, 32768
    buffer_load_dwordx4 v1, s[24:27], s3 offen lds
    s_add_u32 m0, s52, 59392
    s_add_u32 s3, s66, 65536
    buffer_load_dwordx4 v1, s[24:27], s3 offen lds
    s_add_u32 m0, s52, 63488
    s_add_u32 s3, s66, 98304
    buffer_load_dwordx4 v1, s[24:27], s3 offen lds
    s_mov_b32 s3, s65
    s_add_u32 m0, s53, 51200
    s_nop 0
    buffer_load_dwordx4 v2, s[28:31], s3 offen lds
    s_add_u32 m0, s53, 67584
    s_nop 0
    buffer_load_dwordx4 v2, s[32:35], s3 offen lds
    s_add_u32 s3, s3, s50
    s_add_u32 m0, s53, 52224
    s_nop 0
    buffer_load_dwordx4 v2, s[28:31], s3 offen lds
    s_add_u32 m0, s53, 68608
    s_nop 0
    buffer_load_dwordx4 v2, s[32:35], s3 offen lds
    s_add_u32 s3, s3, s50
    s_add_u32 m0, s53, 53248
    s_nop 0
    buffer_load_dwordx4 v3, s[28:31], s3 offen lds
    s_add_u32 m0, s53, 69632
    s_nop 0
    buffer_load_dwordx4 v3, s[32:35], s3 offen lds
    s_add_u32 s3, s3, s50
    s_add_u32 m0, s53, 54272
    s_nop 0
    buffer_load_dwordx4 v3, s[28:31], s3 offen lds
    s_add_u32 m0, s53, 70656
    s_nop 0
    buffer_load_dwordx4 v3, s[32:35], s3 offen lds
    s_add_u32 s65, s65, s51
    s_add_u32 s54, s54, 128
    s_and_b32 s54, s54, 1023
    s_cselect_b32 s65, s65, s49
    s_add_u32 s66, s48, s54
    v_mov_b32 v14, -1
    v_mov_b32 v15, -1
    v_mov_b32 v16, -1
    v_mov_b32 v17, -1
    v_lshlrev_b32 v18, 4, v0
    s_lshl_b32 s3, s2, 2
    s_add_u32 s3, s3, s46
    s_lshl_b32 s3, s3, 11
    s_add_u32 s3, s3, 15728640
    buffer_store_dwordx4 v[14:17], v18, s[36:39], s3 offen offset:0
    buffer_store_dwordx4 v[14:17], v18, s[36:39], s3 offen offset:1024
    s_cmp_lg_u32 s2, 0
    s_cbranch_scc1 proj_kernel_nozf
    s_add_u32 s3, s3, 2088960
    buffer_store_dwordx4 v[14:17], v18, s[36:39], s3 offen offset:0
    buffer_store_dwordx4 v[14:17], v18, s[36:39], s3 offen offset:1024
proj_kernel_nozf:
    s_cmp_ge_u32 s2, 236
    s_cbranch_scc1 proj_kernel_norl1
    s_lshr_b32 s55, s2, 1
    s_cmp_lt_u32 s55, 86
    s_cselect_b32 s40, s16, s8
    s_cselect_b32 s41, s17, s9
    s_mov_b32 s42, 524288
    s_cselect_b32 s42, 1409024, s42
    s_mov_b32 s56, 86
    s_cselect_b32 s56, 0, s56
    s_mov_b32 s57, 14680064
    s_cselect_b32 s57, 12582912, s57
    s_cselect_b32 s58, 3, 2
    s_mov_b32 s59, 1024
    s_cselect_b32 s59, 512, s59
    s_and_b32 s41, s41, 0xffff
    s_mov_b32 s43, 0x20000
    s_sub_u32 s55, s55, s56
    s_lshl_b32 s55, s55, 14
    s_and_b32 s3, s2, 1
    s_lshl_b32 s3, s3, 2
    s_add_u32 s3, s3, s46
    s_lshl_b32 s56, s3, 11
    s_add_u32 s57, s57, s56
    s_add_u32 s57, s57, s55
    s_lshl_b32 s3, s3, 7
    s_add_u32 s55, s55, s3
    v_lshrrev_b32 v40, 3, v0
    v_and_b32 v41, 7, v0
    v_lshlrev_b32 v41, 4, v41
    v_lshl_add_u32 v40, v40, 10, v41
    s_lshl_b32 s56, s46, 11
    s_add_u32 s56, s56, 155648
    s_mov_b32 m0, s56
    s_add_u32 s3, s55, 8192
    buffer_load_dwordx4 v40, s[40:43], s55 offen lds
    s_add_u32 m0, s56, 1024
    s_nop 0
    buffer_load_dwordx4 v40, s[40:43], s3 offen lds
proj_kernel_norl1:
    s_cmp_lg_u32 s46, 0
    s_cbranch_scc1 proj_kernel_nof1
    s_lshl_b32 s62, s44, 2
    buffer_load_dword v12, v13, s[92:95], s62 offen sc1
    s_mul_i32 s63, s44, 6144
    s_add_u32 s63, s63, 19922944
proj_kernel_nof1:
    s_waitcnt vmcnt(14)
    s_barrier
    s_waitcnt vmcnt(0)
    s_cmp_lg_u32 s46, 0
    s_cbranch_scc1 proj_kernel_nof2
proj_kernel_poll:
    v_readfirstlane_b32 s64, v12
    s_cmp_ge_u32 s64, 16
    s_cbranch_scc1 proj_kernel_pok
    buffer_load_dword v12, v13, s[92:95], s62 offen sc1
    s_waitcnt vmcnt(0)
    s_branch proj_kernel_poll
proj_kernel_pok:
    buffer_load_dwordx4 v[32:35], v24, s[36:39], s63 offen sc1
    buffer_load_dwordx4 v[36:39], v25, s[36:39], s63 offen sc1
    buffer_load_dwordx4 v[40:43], v26, s[36:39], s63 offen sc1
proj_kernel_nof2:
    s_barrier
    s_cmp_lg_u32 s46, 0
    s_cbranch_scc1 proj_kernel_nof3
    s_waitcnt vmcnt(2)
    ds_write_b64 v28, v[32:33]
    s_waitcnt vmcnt(1)
    ds_write_b64 v29, v[36:37]
    s_waitcnt vmcnt(0)
    ds_write_b64 v30, v[40:41]
proj_kernel_nof3:
    s_cmp_ge_u32 s2, 236
    s_cbranch_scc1 proj_kernel_norl2
    v_lshrrev_b32 v40, 5, v0
    v_lshlrev_b32 v40, s58, v40
    v_bfe_u32 v41, v0, 2, 2
    v_add_u32 v40, v40, v41
    v_lshlrev_b32 v40, 7, v40
    v_bfe_u32 v41, v0, 4, 1
    v_lshl_add_u32 v40, v41, 5, v40
    v_and_b32 v41, 3, v0
    v_lshl_add_u32 v40, v41, 3, v40
    v_add_u32 v40, s56, v40
    v_add_u32 v41, s59, v40
    v_lshlrev_b32 v42, 4, v0
    ds_read_b64_tr_b16 v[44:45], v40
    ds_read_b64_tr_b16 v[46:47], v41
    ds_read_b64_tr_b16 v[48:49], v40 offset:64
    ds_read_b64_tr_b16 v[50:51], v41 offset:64
    s_waitcnt lgkmcnt(0)
    buffer_store_dwordx4 v[44:47], v42, s[36:39], s57 offen
    buffer_store_dwordx4 v[48:51], v42, s[36:39], s57 offen offset:1024
proj_kernel_norl2:
    s_waitcnt lgkmcnt(0)
    s_barrier
    s_endpgm
proj_kernel_end:
    s_endpgm
.globl attn_kernel
.p2align 8
.type attn_kernel,@function
attn_kernel:
    s_cmp_ge_u32 s2, 256
    s_cbranch_scc1 attn_kernel_end
    s_load_dwordx2 s[20:21], s[0:1], 72
    s_load_dwordx2 s[16:17], s[0:1], 0
    s_load_dwordx2 s[18:19], s[0:1], 56
    v_lshrrev_b32 v1, 6, v0
    v_and_b32 v0, 63, v0
    s_and_b32 s4, s2, 7
    v_readfirstlane_b32 s46, v1
    s_lshr_b32 s5, s2, 3
    s_lshr_b32 s6, s5, 3
    s_lshl_b32 s4, s4, 2
    s_add_u32 s44, s4, s6
    s_and_b32 s45, s5, 7
    s_cmp_ge_u32 s46, 8
    s_cbranch_scc1 attn_kernel_gemm
    v_and_b32 v1, 31, v0
    v_lshlrev_b32 v1, 5, v1
    v_lshrrev_b32 v2, 5, v0
    v_lshl_add_u32 v1, v2, 4, v1
    v_lshlrev_b32 v3, 4, v0
    s_lshl_b32 s7, s44, 16
    s_lshl_b32 s8, s45, 3
    s_add_u32 s8, s8, s46
    s_lshl_b32 s9, s8, 10
    s_add_u32 s9, s9, s7
    s_waitcnt lgkmcnt(0)
    s_mov_b32 s24, s20
    s_and_b32 s25, s21, 0xffff
    s_mov_b32 s26, 25165824
    s_mov_b32 s27, 0x20000
    buffer_load_dwordx4 v[8:11], v1, s[24:27], s9 offen
    s_lshl_b32 s10, s46, 10
    s_add_u32 s11, s7, s10
    s_add_u32 s11, s11, 2097152
    s_add_u32 m0, s10, 0
    s_add_u32 s12, s11, 0
    buffer_load_dwordx4 v1, s[24:27], s12 offen lds
    s_add_u32 m0, s10, 65536
    s_add_u32 s12, s11, 2097152
    buffer_load_dwordx4 v3, s[24:27], s12 offen lds
    v_mov_b32 v32, 0x3f803f80
    v_mov_b32 v33, 0x3f803f80
    v_mov_b32 v34, 0x3f803f80
    v_mov_b32 v35, 0x3f803f80
    s_min_u32 s12, s10, 5120
    s_add_u32 s12, s12, 131072
    v_add_u32 v4, s12, v3
    ds_write_b128 v4, v[32:35]
    v_and_b32 v4, 15, v0
    v_lshlrev_b32 v4, 3, v4
    v_lshl_add_u32 v5, v2, 7, v4
    v_add_u32 v5, 65536, v5
    v_xor_b32 v6, 1, v2
    v_lshl_add_u32 v6, v6, 7, v4
    v_add_u32 v6, 131072, v6
    v_and_b32 v7, 16, v0
    v_cmp_eq_u32 vcc, 0, v7
    v_mov_b32 v7, 4096
    s_mov_b32 s30, 1
    s_lshr_b32 s37, s46, 1
    s_lshl_b32 s36, s37, 17
    s_lshl_b32 s12, s45, 11
    s_add_u32 s36, s36, s12
    s_add_u32 s36, s36, 14680064
    v_cndmask_b32 v112, v6, v5, vcc
    v_cndmask_b32 v7, 0, v7, vcc
    v_mov_b32 v72, 0
    v_mov_b32 v73, 0
    v_mov_b32 v74, 0
    v_mov_b32 v75, 0
    v_mov_b32 v76, 0
    v_mov_b32 v77, 0
    v_mov_b32 v78, 0
    v_mov_b32 v79, 0
    v_mov_b32 v80, 0
    v_mov_b32 v81, 0
    v_mov_b32 v82, 0
    v_mov_b32 v83, 0
    v_mov_b32 v84, 0
    v_mov_b32 v85, 0
    v_mov_b32 v86, 0
    v_mov_b32 v87, 0
    v_mov_b32 v68, 0
    v_mov_b32 v108, 0
    v_mov_b32 v69, 0
    v_mov_b32 v109, 0
    v_mov_b32 v70, 0
    v_mov_b32 v110, 0
    v_mov_b32 v71, 0
    v_mov_b32 v111, 0
    s_waitcnt vmcnt(0) lgkmcnt(0)
    s_barrier
    ds_read_b128 v[136:139], v3 offset:0
    ds_read_b128 v[140:143], v3 offset:1024
    ds_read_b128 v[144:147], v3 offset:2048
    ds_read_b128 v[148:151], v3 offset:3072
    s_waitcnt lgkmcnt(2)
    v_mfma_f32_32x32x16_bf16 v[32:47], v[136:139], v[8:11], 0
    v_mfma_f32_32x32x16_bf16 v[48:63], v[140:143], v[8:11], 0
    s_waitcnt lgkmcnt(0)
    v_mfma_f32_32x32x16_bf16 v[16:31], v[144:147], v[8:11], 0
    v_mfma_f32_32x32x16_bf16 v[120:135], v[148:151], v[8:11], 0
    s_nop 9
    v_max_f32 v4, v32, v33
    v_max3_f32 v4, v34, v35, v4
    v_max3_f32 v4, v36, v37, v4
    v_max3_f32 v4, v38, v39, v4
    v_max3_f32 v4, v40, v41, v4
    v_max3_f32 v4, v42, v43, v4
    v_max3_f32 v4, v44, v45, v4
    v_max3_f32 v4, v46, v47, v4
    v_max3_f32 v4, v48, v49, v4
    v_max3_f32 v4, v50, v51, v4
    v_max3_f32 v4, v52, v53, v4
    v_max3_f32 v4, v54, v55, v4
    v_max3_f32 v4, v56, v57, v4
    v_max3_f32 v4, v58, v59, v4
    v_max3_f32 v4, v60, v61, v4
    v_max3_f32 v4, v62, v63, v4
    v_max3_f32 v4, v16, v17, v4
    v_max3_f32 v4, v18, v19, v4
    v_max3_f32 v4, v20, v21, v4
    v_max3_f32 v4, v22, v23, v4
    v_max3_f32 v4, v24, v25, v4
    v_max3_f32 v4, v26, v27, v4
    v_max3_f32 v4, v28, v29, v4
    v_max3_f32 v4, v30, v31, v4
    v_max3_f32 v4, v120, v121, v4
    v_max3_f32 v4, v122, v123, v4
    v_max3_f32 v4, v124, v125, v4
    v_max3_f32 v4, v126, v127, v4
    v_max3_f32 v4, v128, v129, v4
    v_max3_f32 v4, v130, v131, v4
    v_max3_f32 v4, v132, v133, v4
    v_max3_f32 v4, v134, v135, v4
    s_mov_b32 s33, 0xc2a00000
    s_mov_b32 s34, 0
attn_kernel_run:
    v_mov_b32 v5, v4
    v_lshlrev_b32 v113, 4, v0
    v_mov_b32 v114, v112
    v_permlane32_swap_b32 v4, v5
    ds_read_b128 v[88:91], v113
    ds_read_b128 v[92:95], v113 offset:1024
    v_max_f32 v4, v4, v5
    v_sub_f32 v4, s33, v4
    ds_read_b64_tr_b16 v[96:97], v114 offset:0
    ds_read_b64_tr_b16 v[98:99], v114 offset:256
    ds_read_b64_tr_b16 v[100:101], v114 offset:512
    ds_read_b64_tr_b16 v[102:103], v114 offset:768
    v_mov_b32 v16, v4
    v_mov_b32 v17, v4
    v_mov_b32 v18, v4
    v_mov_b32 v19, v4
    v_mov_b32 v20, v4
    v_mov_b32 v21, v4
    v_mov_b32 v22, v4
    v_mov_b32 v23, v4
    v_mov_b32 v24, v4
    v_mov_b32 v25, v4
    v_mov_b32 v26, v4
    v_mov_b32 v27, v4
    v_mov_b32 v28, v4
    v_mov_b32 v29, v4
    v_mov_b32 v30, v4
    v_mov_b32 v31, v4
    s_mov_b32 s35, 0
    s_waitcnt lgkmcnt(0)
    v_mfma_f32_32x32x16_bf16 v[32:47], v[88:91], v[8:11], v[16:31]
    s_nop 11
    s_cmp_lt_u32 s46, 4
    s_cbranch_scc1 attn_kernel_np
    s_setprio 1
attn_kernel_np:
    s_waitcnt lgkmcnt(0)
.p2align 6
attn_kernel_loop:
    v_exp_f32 v32, v32
    v_exp_f32 v33, v33
    v_exp_f32 v34, v34
    v_exp_f32 v35, v35
    s_waitcnt lgkmcnt(0)
    v_mfma_f32_32x32x16_bf16 v[72:87], v[108:111], v[68:71], v[72:87]
    ds_read_b128 v[88:91], v113 offset:2048
    v_exp_f32 v36, v36
    ds_read_b64_tr_b16 v[104:105], v114 offset:1024
    v_exp_f32 v37, v37
    ds_read_b64_tr_b16 v[106:107], v114 offset:1280
    v_exp_f32 v38, v38
    ds_read_b64_tr_b16 v[108:109], v114 offset:1536
    v_exp_f32 v39, v39
    ds_read_b64_tr_b16 v[110:111], v114 offset:1792
    v_cvt_pk_bf16_f32 v64, v32, v33
    v_mfma_f32_32x32x16_bf16 v[48:63], v[92:95], v[8:11], v[16:31]
    v_exp_f32 v40, v40
    v_cvt_pk_bf16_f32 v65, v34, v35
    v_exp_f32 v41, v41
    v_cvt_pk_bf16_f32 v66, v36, v37
    v_exp_f32 v42, v42
    v_cvt_pk_bf16_f32 v67, v38, v39
    v_exp_f32 v43, v43
    v_exp_f32 v44, v44
    v_mfma_f32_32x32x16_bf16 v[72:87], v[96:99], v[64:67], v[72:87]
    v_exp_f32 v45, v45
    v_exp_f32 v46, v46
    v_exp_f32 v47, v47
    v_cvt_pk_bf16_f32 v68, v40, v41
    v_cvt_pk_bf16_f32 v69, v42, v43
    v_cvt_pk_bf16_f32 v70, v44, v45
    v_cvt_pk_bf16_f32 v71, v46, v47
    v_exp_f32 v48, v48
    v_exp_f32 v49, v49
    v_exp_f32 v50, v50
    v_exp_f32 v51, v51
    s_waitcnt lgkmcnt(0)
    v_mfma_f32_32x32x16_bf16 v[72:87], v[100:103], v[68:71], v[72:87]
    ds_read_b128 v[92:95], v113 offset:3072
    v_exp_f32 v52, v52
    ds_read_b64_tr_b16 v[96:97], v114 offset:2048
    v_exp_f32 v53, v53
    ds_read_b64_tr_b16 v[98:99], v114 offset:2304
    v_exp_f32 v54, v54
    ds_read_b64_tr_b16 v[100:101], v114 offset:2560
    v_exp_f32 v55, v55
    ds_read_b64_tr_b16 v[102:103], v114 offset:2816
    v_cvt_pk_bf16_f32 v64, v48, v49
    v_mfma_f32_32x32x16_bf16 v[32:47], v[88:91], v[8:11], v[16:31]
    v_exp_f32 v56, v56
    v_cvt_pk_bf16_f32 v65, v50, v51
    v_exp_f32 v57, v57
    v_cvt_pk_bf16_f32 v66, v52, v53
    v_exp_f32 v58, v58
    v_cvt_pk_bf16_f32 v67, v54, v55
    v_exp_f32 v59, v59
    v_exp_f32 v60, v60
    v_mfma_f32_32x32x16_bf16 v[72:87], v[104:107], v[64:67], v[72:87]
    v_exp_f32 v61, v61
    v_exp_f32 v62, v62
    v_exp_f32 v63, v63
    v_cvt_pk_bf16_f32 v68, v56, v57
    v_cvt_pk_bf16_f32 v69, v58, v59
    v_cvt_pk_bf16_f32 v70, v60, v61
    v_cvt_pk_bf16_f32 v71, v62, v63
    v_exp_f32 v32, v32
    v_exp_f32 v33, v33
    v_exp_f32 v34, v34
    v_exp_f32 v35, v35
    s_waitcnt lgkmcnt(0)
    v_mfma_f32_32x32x16_bf16 v[72:87], v[108:111], v[68:71], v[72:87]
    ds_read_b128 v[88:91], v113 offset:4096
    v_exp_f32 v36, v36
    ds_read_b64_tr_b16 v[104:105], v114 offset:3072
    v_exp_f32 v37, v37
    ds_read_b64_tr_b16 v[106:107], v114 offset:3328
    v_exp_f32 v38, v38
    ds_read_b64_tr_b16 v[108:109], v114 offset:3584
    v_exp_f32 v39, v39
    ds_read_b64_tr_b16 v[110:111], v114 offset:3840
    v_cvt_pk_bf16_f32 v64, v32, v33
    v_mfma_f32_32x32x16_bf16 v[48:63], v[92:95], v[8:11], v[16:31]
    v_exp_f32 v40, v40
    v_cvt_pk_bf16_f32 v65, v34, v35
    v_exp_f32 v41, v41
    v_cvt_pk_bf16_f32 v66, v36, v37
    v_exp_f32 v42, v42
    v_cvt_pk_bf16_f32 v67, v38, v39
    v_exp_f32 v43, v43
    v_exp_f32 v44, v44
    v_mfma_f32_32x32x16_bf16 v[72:87], v[96:99], v[64:67], v[72:87]
    v_exp_f32 v45, v45
    v_exp_f32 v46, v46
    v_exp_f32 v47, v47
    v_cvt_pk_bf16_f32 v68, v40, v41
    v_cvt_pk_bf16_f32 v69, v42, v43
    v_cvt_pk_bf16_f32 v70, v44, v45
    v_cvt_pk_bf16_f32 v71, v46, v47
    v_exp_f32 v48, v48
    v_exp_f32 v49, v49
    v_exp_f32 v50, v50
    v_exp_f32 v51, v51
    s_waitcnt lgkmcnt(0)
    v_mfma_f32_32x32x16_bf16 v[72:87], v[100:103], v[68:71], v[72:87]
    ds_read_b128 v[92:95], v113 offset:5120
    v_exp_f32 v52, v52
    ds_read_b64_tr_b16 v[96:97], v114 offset:4096
    v_exp_f32 v53, v53
    ds_read_b64_tr_b16 v[98:99], v114 offset:4352
    v_exp_f32 v54, v54
    ds_read_b64_tr_b16 v[100:101], v114 offset:4608
    v_exp_f32 v55, v55
    ds_read_b64_tr_b16 v[102:103], v114 offset:4864
    v_cvt_pk_bf16_f32 v64, v48, v49
    v_mfma_f32_32x32x16_bf16 v[32:47], v[88:91], v[8:11], v[16:31]
    v_exp_f32 v56, v56
    v_cvt_pk_bf16_f32 v65, v50, v51
    v_exp_f32 v57, v57
    v_cvt_pk_bf16_f32 v66, v52, v53
    v_exp_f32 v58, v58
    v_cvt_pk_bf16_f32 v67, v54, v55
    v_exp_f32 v59, v59
    v_exp_f32 v60, v60
    v_mfma_f32_32x32x16_bf16 v[72:87], v[104:107], v[64:67], v[72:87]
    v_exp_f32 v61, v61
    v_exp_f32 v62, v62
    v_exp_f32 v63, v63
    v_cvt_pk_bf16_f32 v68, v56, v57
    v_cvt_pk_bf16_f32 v69, v58, v59
    v_cvt_pk_bf16_f32 v70, v60, v61
    v_cvt_pk_bf16_f32 v71, v62, v63
    v_add_u32 v113, 4096, v113
    v_add_u32 v114, v7, v114
    s_add_u32 s35, s35, 1
    s_cmp_eq_u32 s35, s30
    s_cbranch_scc1 attn_kernel_ev
    s_cmp_lt_u32 s35, 16
    s_cbranch_scc1 attn_kernel_loop
    v_mfma_f32_32x32x16_bf16 v[72:87], v[108:111], v[68:71], v[72:87]
    s_mov_b32 s12, 0x7a800000
    s_lshl_b32 s9, s8, 5
    s_add_u32 s9, s9, s44
    s_lshl_b32 s9, s9, 10
    s_add_u32 s9, s9, 15728640
    s_nop 6
    v_max3_f32 v4, abs(v72), abs(v73), v80
    v_max3_f32 v4, abs(v74), abs(v75), v4
    v_max3_f32 v4, abs(v76), abs(v77), v4
    v_max3_f32 v4, abs(v78), abs(v79), v4
    v_add_f32 v5, v72, v80
    v_add_f32 v5, v73, v5
    v_add_f32 v5, v74, v5
    v_add_f32 v5, v75, v5
    v_add_f32 v5, v76, v5
    v_add_f32 v5, v77, v5
    v_add_f32 v5, v78, v5
    v_add_f32 v5, v79, v5
    v_cmp_ngt_f32 vcc, s12, v4
    v_cmp_u_f32 s[14:15], v5, v5
    v_rcp_f32 v6, v80
    s_nop 3
    s_or_b64 s[14:15], vcc, s[14:15]
    s_cselect_b32 s13, 1, 0
    s_andn2_b32 s13, s13, s34
    s_cbranch_scc1 attn_kernel_slow
    v_mul_f32 v72, v6, v72
    v_mul_f32 v73, v6, v73
    v_mul_f32 v74, v6, v74
    v_mul_f32 v75, v6, v75
    v_mul_f32 v76, v6, v76
    v_mul_f32 v77, v6, v77
    v_mul_f32 v78, v6, v78
    v_mul_f32 v79, v6, v79
    v_cvt_pk_bf16_f32 v64, v72, v73
    v_cvt_pk_bf16_f32 v65, v74, v75
    v_cvt_pk_bf16_f32 v66, v76, v77
    v_cvt_pk_bf16_f32 v67, v78, v79
    v_min_u32 v64, -2, v64
    v_min_u32 v65, -2, v65
    v_min_u32 v66, -2, v66
    v_min_u32 v67, -2, v67
    buffer_store_dwordx4 v[64:67], v3, s[24:27], s9 offen sc1
    buffer_load_dwordx4 v[8:11], v3, s[24:27], s36 offen offset:0
    buffer_load_dwordx4 v[12:15], v3, s[24:27], s36 offen offset:1024
    s_add_u32 s36, s36, 16384
    buffer_load_dwordx4 v[16:19], v3, s[24:27], s36 offen offset:0
    buffer_load_dwordx4 v[20:23], v3, s[24:27], s36 offen offset:1024
    s_add_u32 s36, s36, 16384
    s_lshl_b32 s12, s44, 1
    s_and_b32 s13, s46, 1
    s_add_u32 s12, s12, s13
    s_lshl_b32 s12, s12, 15
    s_lshl_b32 s14, s37, 13
    s_add_u32 s12, s12, s14
    s_add_u32 s12, s12, 15728640
    s_add_u32 s14, s12, 4096
    s_lshl_b32 s13, s13, 3
    s_add_u32 s13, s13, s37
    s_lshl_b32 s13, s13, 12
    v_add_u32 v4, s13, v3
    s_barrier
attn_kernel_F0:
    buffer_load_dwordx4 v[24:27], v3, s[24:27], s12 offen offset:0 sc1
    buffer_load_dwordx4 v[28:31], v3, s[24:27], s12 offen offset:1024 sc1
    buffer_load_dwordx4 v[32:35], v3, s[24:27], s12 offen offset:2048 sc1
    buffer_load_dwordx4 v[36:39], v3, s[24:27], s12 offen offset:3072 sc1
    buffer_load_dwordx4 v[40:43], v3, s[24:27], s14 offen offset:0 sc1
    buffer_load_dwordx4 v[44:47], v3, s[24:27], s14 offen offset:1024 sc1
    buffer_load_dwordx4 v[48:51], v3, s[24:27], s14 offen offset:2048 sc1
    buffer_load_dwordx4 v[52:55], v3, s[24:27], s14 offen offset:3072 sc1
attn_kernel_C0:
    s_waitcnt vmcnt(7)
    v_max3_u32 v5, v24, v25, v26
    v_max_u32 v5, v27, v5
    v_cmp_eq_u32 vcc, -1, v5
    s_nop 3
    s_cbranch_vccnz attn_kernel_L0
    v_mfma_f32_32x32x16_bf16 v[68:83], v[120:123], v[24:27], 0
    v_mfma_f32_32x32x16_bf16 v[84:99], v[124:127], v[24:27], 0
attn_kernel_C1:
    s_waitcnt vmcnt(6)
    v_max3_u32 v5, v28, v29, v30
    v_max_u32 v5, v31, v5
    v_cmp_eq_u32 vcc, -1, v5
    s_nop 3
    s_cbranch_vccnz attn_kernel_L1
    v_mfma_f32_32x32x16_bf16 v[68:83], v[128:131], v[28:31], v[68:83]
    v_mfma_f32_32x32x16_bf16 v[84:99], v[132:135], v[28:31], v[84:99]
attn_kernel_C2:
    s_waitcnt vmcnt(5)
    v_max3_u32 v5, v32, v33, v34
    v_max_u32 v5, v35, v5
    v_cmp_eq_u32 vcc, -1, v5
    s_nop 3
    s_cbranch_vccnz attn_kernel_L2
    v_mfma_f32_32x32x16_bf16 v[68:83], v[136:139], v[32:35], v[68:83]
    v_mfma_f32_32x32x16_bf16 v[84:99], v[140:143], v[32:35], v[84:99]
attn_kernel_C3:
    s_waitcnt vmcnt(4)
    v_max3_u32 v5, v36, v37, v38
    v_max_u32 v5, v39, v5
    v_cmp_eq_u32 vcc, -1, v5
    s_nop 3
    s_cbranch_vccnz attn_kernel_L3
    v_mfma_f32_32x32x16_bf16 v[68:83], v[144:147], v[36:39], v[68:83]
    v_mfma_f32_32x32x16_bf16 v[84:99], v[148:151], v[36:39], v[84:99]
attn_kernel_C4:
    s_waitcnt vmcnt(3)
    v_max3_u32 v5, v40, v41, v42
    v_max_u32 v5, v43, v5
    v_cmp_eq_u32 vcc, -1, v5
    s_nop 3
    s_cbranch_vccnz attn_kernel_L4
    v_mfma_f32_32x32x16_bf16 v[68:83], v[152:155], v[40:43], v[68:83]
    v_mfma_f32_32x32x16_bf16 v[84:99], v[156:159], v[40:43], v[84:99]
attn_kernel_C5:
    s_waitcnt vmcnt(2)
    v_max3_u32 v5, v44, v45, v46
    v_max_u32 v5, v47, v5
    v_cmp_eq_u32 vcc, -1, v5
    s_nop 3
    s_cbranch_vccnz attn_kernel_L5
    v_mfma_f32_32x32x16_bf16 v[68:83], v[160:163], v[44:47], v[68:83]
    v_mfma_f32_32x32x16_bf16 v[84:99], v[164:167], v[44:47], v[84:99]
attn_kernel_C6:
    s_waitcnt vmcnt(1)
    v_max3_u32 v5, v48, v49, v50
    v_max_u32 v5, v51, v5
    v_cmp_eq_u32 vcc, -1, v5
    s_nop 3
    s_cbranch_vccnz attn_kernel_L6
    v_mfma_f32_32x32x16_bf16 v[68:83], v[8:11], v[48:51], v[68:83]
    v_mfma_f32_32x32x16_bf16 v[84:99], v[12:15], v[48:51], v[84:99]
attn_kernel_C7:
    s_waitcnt vmcnt(0)
    v_max3_u32 v5, v52, v53, v54
    v_max_u32 v5, v55, v5
    v_cmp_eq_u32 vcc, -1, v5
    s_nop 3
    s_cbranch_vccnz attn_kernel_L7
    v_mfma_f32_32x32x16_bf16 v[68:83], v[16:19], v[52:55], v[68:83]
    v_mfma_f32_32x32x16_bf16 v[84:99], v[20:23], v[52:55], v[84:99]
    s_nop 10
    ds_write_b128 v4, v[68:71] offset:0
    ds_write_b128 v4, v[72:75] offset:1024
    ds_write_b128 v4, v[76:79] offset:2048
    ds_write_b128 v4, v[80:83] offset:3072
    ds_write_b128 v4, v[84:87] offset:16384
    ds_write_b128 v4, v[88:91] offset:17408
    ds_write_b128 v4, v[92:95] offset:18432
    ds_write_b128 v4, v[96:99] offset:19456
    s_waitcnt lgkmcnt(0)
    s_barrier
    s_endpgm
attn_kernel_L0:
    s_waitcnt vmcnt(0)
    buffer_load_dwordx4 v[24:27], v3, s[24:27], s12 offen offset:0 sc1
    buffer_load_dwordx4 v[28:31], v3, s[24:27], s12 offen offset:1024 sc1
    buffer_load_dwordx4 v[32:35], v3, s[24:27], s12 offen offset:2048 sc1
    buffer_load_dwordx4 v[36:39], v3, s[24:27], s12 offen offset:3072 sc1
    buffer_load_dwordx4 v[40:43], v3, s[24:27], s14 offen offset:0 sc1
    buffer_load_dwordx4 v[44:47], v3, s[24:27], s14 offen offset:1024 sc1
    buffer_load_dwordx4 v[48:51], v3, s[24:27], s14 offen offset:2048 sc1
    buffer_load_dwordx4 v[52:55], v3, s[24:27], s14 offen offset:3072 sc1
    s_branch attn_kernel_C0
attn_kernel_L1:
    s_waitcnt vmcnt(0)
    buffer_load_dwordx4 v[28:31], v3, s[24:27], s12 offen offset:1024 sc1
    buffer_load_dwordx4 v[32:35], v3, s[24:27], s12 offen offset:2048 sc1
    buffer_load_dwordx4 v[36:39], v3, s[24:27], s12 offen offset:3072 sc1
    buffer_load_dwordx4 v[40:43], v3, s[24:27], s14 offen offset:0 sc1
    buffer_load_dwordx4 v[44:47], v3, s[24:27], s14 offen offset:1024 sc1
    buffer_load_dwordx4 v[48:51], v3, s[24:27], s14 offen offset:2048 sc1
    buffer_load_dwordx4 v[52:55], v3, s[24:27], s14 offen offset:3072 sc1
    s_branch attn_kernel_C1
attn_kernel_L2:
    s_waitcnt vmcnt(0)
    buffer_load_dwordx4 v[32:35], v3, s[24:27], s12 offen offset:2048 sc1
    buffer_load_dwordx4 v[36:39], v3, s[24:27], s12 offen offset:3072 sc1
    buffer_load_dwordx4 v[40:43], v3, s[24:27], s14 offen offset:0 sc1
    buffer_load_dwordx4 v[44:47], v3, s[24:27], s14 offen offset:1024 sc1
    buffer_load_dwordx4 v[48:51], v3, s[24:27], s14 offen offset:2048 sc1
    buffer_load_dwordx4 v[52:55], v3, s[24:27], s14 offen offset:3072 sc1
    s_branch attn_kernel_C2
attn_kernel_L3:
    s_waitcnt vmcnt(0)
    buffer_load_dwordx4 v[36:39], v3, s[24:27], s12 offen offset:3072 sc1
    buffer_load_dwordx4 v[40:43], v3, s[24:27], s14 offen offset:0 sc1
    buffer_load_dwordx4 v[44:47], v3, s[24:27], s14 offen offset:1024 sc1
    buffer_load_dwordx4 v[48:51], v3, s[24:27], s14 offen offset:2048 sc1
    buffer_load_dwordx4 v[52:55], v3, s[24:27], s14 offen offset:3072 sc1
    s_branch attn_kernel_C3
attn_kernel_L4:
    s_waitcnt vmcnt(0)
    buffer_load_dwordx4 v[40:43], v3, s[24:27], s14 offen offset:0 sc1
    buffer_load_dwordx4 v[44:47], v3, s[24:27], s14 offen offset:1024 sc1
    buffer_load_dwordx4 v[48:51], v3, s[24:27], s14 offen offset:2048 sc1
    buffer_load_dwordx4 v[52:55], v3, s[24:27], s14 offen offset:3072 sc1
    s_branch attn_kernel_C4
attn_kernel_L5:
    s_waitcnt vmcnt(0)
    buffer_load_dwordx4 v[44:47], v3, s[24:27], s14 offen offset:1024 sc1
    buffer_load_dwordx4 v[48:51], v3, s[24:27], s14 offen offset:2048 sc1
    buffer_load_dwordx4 v[52:55], v3, s[24:27], s14 offen offset:3072 sc1
    s_branch attn_kernel_C5
attn_kernel_L6:
    s_waitcnt vmcnt(0)
    buffer_load_dwordx4 v[48:51], v3, s[24:27], s14 offen offset:2048 sc1
    buffer_load_dwordx4 v[52:55], v3, s[24:27], s14 offen offset:3072 sc1
    s_branch attn_kernel_C6
attn_kernel_L7:
    s_waitcnt vmcnt(0)
    buffer_load_dwordx4 v[52:55], v3, s[24:27], s14 offen offset:3072 sc1
    s_branch attn_kernel_C7
attn_kernel_ev:
    s_cmp_eq_u32 s35, 3
    s_cbranch_scc1 attn_kernel_e3
    s_cmp_eq_u32 s35, 11
    s_cbranch_scc1 attn_kernel_e11
    s_cmp_eq_u32 s35, 12
    s_cbranch_scc1 attn_kernel_e12
    s_cmp_eq_u32 s35, 13
    s_cbranch_scc1 attn_kernel_e13
    s_cmp_eq_u32 s35, 14
    s_cbranch_scc1 attn_kernel_e14
attn_kernel_e1:
    s_mov_b32 s30, 3
    v_mov_b32 v115, 137216
attn_kernel_b2l1:
    ds_read_b128 v[116:119], v115
    s_waitcnt lgkmcnt(0)
    v_and_b32 v116, v116, v117
    v_and_b32 v118, v118, v119
    v_and_b32 v116, v116, v118
    s_nop 0
    v_readfirstlane_b32 s31, v116
    s_bitcmp1_b32 s31, 0
    s_cbranch_scc0 attn_kernel_b2l1
    s_branch attn_kernel_loop
attn_kernel_e3:
    s_mov_b32 s30, 11
    v_mov_b32 v115, 137216
attn_kernel_b2l3:
    ds_read_b128 v[116:119], v115
    s_waitcnt lgkmcnt(0)
    v_and_b32 v116, v116, v117
    v_and_b32 v118, v118, v119
    v_and_b32 v116, v116, v118
    s_nop 0
    v_readfirstlane_b32 s31, v116
    s_bitcmp1_b32 s31, 1
    s_cbranch_scc0 attn_kernel_b2l3
    s_branch attn_kernel_loop
attn_kernel_e11:
    s_mov_b32 s30, 12
    s_setprio 0
    s_branch attn_kernel_loop
attn_kernel_e12:
    s_mov_b32 s30, 13
    buffer_load_dwordx4 v[120:123], v3, s[24:27], s36 offen offset:0
    buffer_load_dwordx4 v[124:127], v3, s[24:27], s36 offen offset:1024
    s_add_u32 s36, s36, 16384
    buffer_load_dwordx4 v[128:131], v3, s[24:27], s36 offen offset:0
    buffer_load_dwordx4 v[132:135], v3, s[24:27], s36 offen offset:1024
    s_add_u32 s36, s36, 16384
    s_branch attn_kernel_loop
attn_kernel_e13:
    s_mov_b32 s30, 14
    buffer_load_dwordx4 v[136:139], v3, s[24:27], s36 offen offset:0
    buffer_load_dwordx4 v[140:143], v3, s[24:27], s36 offen offset:1024
    s_add_u32 s36, s36, 16384
    buffer_load_dwordx4 v[144:147], v3, s[24:27], s36 offen offset:0
    buffer_load_dwordx4 v[148:151], v3, s[24:27], s36 offen offset:1024
    s_add_u32 s36, s36, 16384
    s_branch attn_kernel_loop
attn_kernel_e14:
    s_mov_b32 s30, -1
    buffer_load_dwordx4 v[152:155], v3, s[24:27], s36 offen offset:0
    buffer_load_dwordx4 v[156:159], v3, s[24:27], s36 offen offset:1024
    s_add_u32 s36, s36, 16384
    buffer_load_dwordx4 v[160:163], v3, s[24:27], s36 offen offset:0
    buffer_load_dwordx4 v[164:167], v3, s[24:27], s36 offen offset:1024
    s_add_u32 s36, s36, 16384
    s_branch attn_kernel_loop
attn_kernel_slow:
    s_mov_b32 s34, 1
    s_mov_b32 s33, 0
    s_mov_b32 s30, -1
    s_mov_b32 s35, 0
    v_mov_b32 v113, v3
    v_mov_b32 v4, 0xff800000
attn_kernel_sl:
    ds_read_b128 v[88:91], v113
    v_add_u32 v113, 1024, v113
    s_waitcnt lgkmcnt(0)
    v_mfma_f32_32x32x16_bf16 v[32:47], v[88:91], v[8:11], 0
    s_nop 11
    v_max3_f32 v4, v32, v33, v4
    v_max3_f32 v4, v34, v35, v4
    v_max3_f32 v4, v36, v37, v4
    v_max3_f32 v4, v38, v39, v4
    v_max3_f32 v4, v40, v41, v4
    v_max3_f32 v4, v42, v43, v4
    v_max3_f32 v4, v44, v45, v4
    v_max3_f32 v4, v46, v47, v4
    s_add_u32 s35, s35, 1
    s_cmp_lt_u32 s35, 64
    s_cbranch_scc1 attn_kernel_sl
    v_mov_b32 v72, 0
    v_mov_b32 v73, 0
    v_mov_b32 v74, 0
    v_mov_b32 v75, 0
    v_mov_b32 v76, 0
    v_mov_b32 v77, 0
    v_mov_b32 v78, 0
    v_mov_b32 v79, 0
    v_mov_b32 v80, 0
    v_mov_b32 v81, 0
    v_mov_b32 v82, 0
    v_mov_b32 v83, 0
    v_mov_b32 v84, 0
    v_mov_b32 v85, 0
    v_mov_b32 v86, 0
    v_mov_b32 v87, 0
    v_mov_b32 v68, 0
    v_mov_b32 v108, 0
    v_mov_b32 v69, 0
    v_mov_b32 v109, 0
    v_mov_b32 v70, 0
    v_mov_b32 v110, 0
    v_mov_b32 v71, 0
    v_mov_b32 v111, 0
    s_branch attn_kernel_run
attn_kernel_gemm:
    s_sub_u32 s46, s46, 8
    v_and_b32 v2, 31, v0
    v_lshlrev_b32 v2, 5, v2
    v_lshrrev_b32 v3, 5, v0
    v_lshl_add_u32 v2, v3, 4, v2
    v_lshlrev_b32 v1, 4, v0
    s_lshl_b32 s7, s44, 16
    s_lshl_b32 s10, s46, 11
    s_add_u32 s11, s7, s10
    s_add_u32 s11, s11, 2097152
    s_waitcnt lgkmcnt(0)
    s_mov_b32 s24, s20
    s_and_b32 s25, s21, 0xffff
    s_mov_b32 s26, 25165824
    s_mov_b32 s27, 0x20000
    s_lshl_b32 s12, s46, 2
    s_add_u32 s12, s12, 137216
    v_mov_b32 v3, s12
    v_mov_b32 v5, 0
    ds_write_b32 v3, v5
    v_mov_b32 v5, 1
    s_lshr_b32 s47, s46, 1
    s_and_b32 s48, s46, 1
    s_lshl_b32 s13, s44, 1
    s_add_u32 s13, s13, s47
    s_mul_i32 s8, s13, 88064
    s_add_u32 s8, s8, 6291456
    s_lshl_b32 s14, s45, 1
    s_add_u32 s14, s14, s48
    s_lshl_b32 s9, s14, 10
    s_add_u32 s9, s9, 12582912
    s_lshl_b32 s13, s13, 15
    s_lshl_b32 s15, s14, 6
    s_add_u32 s13, s13, s15
    v_and_b32 v6, 31, v0
    v_lshlrev_b32 v6, 10, v6
    v_lshrrev_b32 v7, 5, v0
    v_lshl_add_u32 v6, v7, 4, v6
    s_mov_b32 s28, s16
    s_and_b32 s29, s17, 0xffff
    s_mov_b32 s30, 2097152
    s_mov_b32 s31, 0x20000
    s_mov_b32 s32, s18
    s_and_b32 s33, s19, 0xffff
    s_mov_b32 s34, 2097152
    s_mov_b32 s35, 0x20000
    s_waitcnt lgkmcnt(0)
    s_barrier
    s_add_u32 m0, s10, 8192
    s_add_u32 s12, s11, 8192
    buffer_load_dwordx4 v2, s[24:27], s12 offen offset:0 lds
    buffer_load_dwordx4 v2, s[24:27], s12 offen offset:1024 lds
    s_add_u32 m0, s10, 73728
    s_add_u32 s12, s11, 2105344
    buffer_load_dwordx4 v1, s[24:27], s12 offen offset:0 lds
    buffer_load_dwordx4 v1, s[24:27], s12 offen offset:1024 lds
    s_add_u32 m0, s10, 16384
    s_add_u32 s12, s11, 16384
    buffer_load_dwordx4 v2, s[24:27], s12 offen offset:0 lds
    buffer_load_dwordx4 v2, s[24:27], s12 offen offset:1024 lds
    s_add_u32 m0, s10, 81920
    s_add_u32 s12, s11, 2113536
    buffer_load_dwordx4 v1, s[24:27], s12 offen offset:0 lds
    buffer_load_dwordx4 v1, s[24:27], s12 offen offset:1024 lds
    s_add_u32 m0, s10, 24576
    s_add_u32 s12, s11, 24576
    buffer_load_dwordx4 v2, s[24:27], s12 offen offset:0 lds
    buffer_load_dwordx4 v2, s[24:27], s12 offen offset:1024 lds
    s_add_u32 m0, s10, 90112
    s_add_u32 s12, s11, 2121728
    buffer_load_dwordx4 v1, s[24:27], s12 offen offset:0 lds
    buffer_load_dwordx4 v1, s[24:27], s12 offen offset:1024 lds
    s_add_u32 m0, s10, 32768
    s_add_u32 s12, s11, 32768
    buffer_load_dwordx4 v2, s[24:27], s12 offen offset:0 lds
    buffer_load_dwordx4 v2, s[24:27], s12 offen offset:1024 lds
    s_add_u32 m0, s10, 98304
    s_add_u32 s12, s11, 2129920
    buffer_load_dwordx4 v1, s[24:27], s12 offen offset:0 lds
    buffer_load_dwordx4 v1, s[24:27], s12 offen offset:1024 lds
    s_waitcnt vmcnt(12)
    ds_write_b32 v3, v5
    v_mov_b32 v4, 3
    s_add_u32 m0, s10, 40960
    s_add_u32 s12, s11, 40960
    buffer_load_dwordx4 v2, s[24:27], s12 offen offset:0 lds
    buffer_load_dwordx4 v2, s[24:27], s12 offen offset:1024 lds
    s_add_u32 m0, s10, 106496
    s_add_u32 s12, s11, 2138112
    buffer_load_dwordx4 v1, s[24:27], s12 offen offset:0 lds
    buffer_load_dwordx4 v1, s[24:27], s12 offen offset:1024 lds
    s_add_u32 m0, s10, 49152
    s_add_u32 s12, s11, 49152
    buffer_load_dwordx4 v2, s[24:27], s12 offen offset:0 lds
    buffer_load_dwordx4 v2, s[24:27], s12 offen offset:1024 lds
    s_add_u32 m0, s10, 114688
    s_add_u32 s12, s11, 2146304
    buffer_load_dwordx4 v1, s[24:27], s12 offen offset:0 lds
    buffer_load_dwordx4 v1, s[24:27], s12 offen offset:1024 lds
    s_add_u32 m0, s10, 57344
    s_add_u32 s12, s11, 57344
    buffer_load_dwordx4 v2, s[24:27], s12 offen offset:0 lds
    buffer_load_dwordx4 v2, s[24:27], s12 offen offset:1024 lds
    s_add_u32 m0, s10, 122880
    s_add_u32 s12, s11, 2154496
    buffer_load_dwordx4 v1, s[24:27], s12 offen offset:0 lds
    buffer_load_dwordx4 v1, s[24:27], s12 offen offset:1024 lds
    buffer_load_dwordx4 v[24:27], v1, s[24:27], s9 offen
    buffer_load_dwordx4 v[28:31], v1, s[24:27], s8 offen offset:0
    s_add_u32 s9, s9, 16384
    buffer_load_dwordx4 v[32:35], v1, s[24:27], s9 offen
    buffer_load_dwordx4 v[36:39], v1, s[24:27], s8 offen offset:1024
    s_add_u32 s9, s9, 16384
    buffer_load_dwordx4 v[40:43], v1, s[24:27], s9 offen
    buffer_load_dwordx4 v[44:47], v1, s[24:27], s8 offen offset:2048
    s_add_u32 s9, s9, 16384
    buffer_load_dwordx4 v[48:51], v1, s[24:27], s9 offen
    buffer_load_dwordx4 v[52:55], v1, s[24:27], s8 offen offset:3072
    s_add_u32 s9, s9, 16384
    s_add_u32 s8, s8, 4096
    buffer_load_dwordx4 v[56:59], v1, s[24:27], s9 offen
    buffer_load_dwordx4 v[60:63], v1, s[24:27], s8 offen offset:0
    s_add_u32 s9, s9, 16384
    buffer_load_dwordx4 v[64:67], v1, s[24:27], s9 offen
    buffer_load_dwordx4 v[68:71], v1, s[24:27], s8 offen offset:1024
    s_add_u32 s9, s9, 16384
    buffer_load_dwordx4 v[72:75], v1, s[24:27], s9 offen
    buffer_load_dwordx4 v[76:79], v1, s[24:27], s8 offen offset:2048
    s_add_u32 s9, s9, 16384
    buffer_load_dwordx4 v[80:83], v1, s[24:27], s9 offen
    buffer_load_dwordx4 v[84:87], v1, s[24:27], s8 offen offset:3072
    s_add_u32 s9, s9, 16384
    s_add_u32 s8, s8, 4096
    buffer_load_dwordx4 v[88:91], v1, s[24:27], s9 offen
    buffer_load_dwordx4 v[92:95], v1, s[24:27], s8 offen offset:0
    s_add_u32 s9, s9, 16384
    buffer_load_dwordx4 v[96:99], v1, s[24:27], s9 offen
    buffer_load_dwordx4 v[100:103], v1, s[24:27], s8 offen offset:1024
    s_add_u32 s9, s9, 16384
    buffer_load_dwordx4 v[104:107], v1, s[24:27], s9 offen
    buffer_load_dwordx4 v[108:111], v1, s[24:27], s8 offen offset:2048
    s_add_u32 s9, s9, 16384
    buffer_load_dwordx4 v[112:115], v1, s[24:27], s9 offen
    buffer_load_dwordx4 v[116:119], v1, s[24:27], s8 offen offset:3072
    s_add_u32 s9, s9, 16384
    s_waitcnt vmcnt(24)
    ds_write_b32 v3, v4
    s_waitcnt vmcnt(22)
    v_mfma_f32_32x32x16_bf16 v[8:23], v[24:27], v[28:31], 0
    s_add_u32 s8, s8, 4096
    buffer_load_dwordx4 v[24:27], v1, s[24:27], s9 offen
    buffer_load_dwordx4 v[28:31], v1, s[24:27], s8 offen offset:0
    s_add_u32 s9, s9, 16384
    s_waitcnt vmcnt(22)
    v_mfma_f32_32x32x16_bf16 v[8:23], v[32:35], v[36:39], v[8:23]
    buffer_load_dwordx4 v[32:35], v1, s[24:27], s9 offen
    buffer_load_dwordx4 v[36:39], v1, s[24:27], s8 offen offset:1024
    s_add_u32 s9, s9, 16384
    s_waitcnt vmcnt(22)
    v_mfma_f32_32x32x16_bf16 v[8:23], v[40:43], v[44:47], v[8:23]
    buffer_load_dwordx4 v[40:43], v1, s[24:27], s9 offen
    buffer_load_dwordx4 v[44:47], v1, s[24:27], s8 offen offset:2048
    s_add_u32 s9, s9, 16384
    s_waitcnt vmcnt(22)
    v_mfma_f32_32x32x16_bf16 v[8:23], v[48:51], v[52:55], v[8:23]
    buffer_load_dwordx4 v[48:51], v1, s[24:27], s9 offen
    buffer_load_dwordx4 v[52:55], v1, s[24:27], s8 offen offset:3072
    s_add_u32 s9, s9, 16384
    s_waitcnt vmcnt(22)
    v_mfma_f32_32x32x16_bf16 v[8:23], v[56:59], v[60:63], v[8:23]
    s_add_u32 s8, s8, 4096
    buffer_load_dwordx4 v[56:59], v1, s[24:27], s9 offen
    buffer_load_dwordx4 v[60:63], v1, s[24:27], s8 offen offset:0
    s_add_u32 s9, s9, 16384
    s_waitcnt vmcnt(22)
    v_mfma_f32_32x32x16_bf16 v[8:23], v[64:67], v[68:71], v[8:23]
    buffer_load_dwordx4 v[64:67], v1, s[24:27], s9 offen
    buffer_load_dwordx4 v[68:71], v1, s[24:27], s8 offen offset:1024
    s_add_u32 s9, s9, 16384
    s_waitcnt vmcnt(22)
    v_mfma_f32_32x32x16_bf16 v[8:23], v[72:75], v[76:79], v[8:23]
    buffer_load_dwordx4 v[72:75], v1, s[24:27], s9 offen
    buffer_load_dwordx4 v[76:79], v1, s[24:27], s8 offen offset:2048
    s_add_u32 s9, s9, 16384
    s_waitcnt vmcnt(22)
    v_mfma_f32_32x32x16_bf16 v[8:23], v[80:83], v[84:87], v[8:23]
    buffer_load_dwordx4 v[80:83], v1, s[24:27], s9 offen
    buffer_load_dwordx4 v[84:87], v1, s[24:27], s8 offen offset:3072
    s_add_u32 s9, s9, 16384
    s_waitcnt vmcnt(22)
    v_mfma_f32_32x32x16_bf16 v[8:23], v[88:91], v[92:95], v[8:23]
    s_add_u32 s8, s8, 4096
    buffer_load_dwordx4 v[88:91], v1, s[24:27], s9 offen
    buffer_load_dwordx4 v[92:95], v1, s[24:27], s8 offen offset:0
    s_add_u32 s9, s9, 16384
    s_waitcnt vmcnt(22)
    v_mfma_f32_32x32x16_bf16 v[8:23], v[96:99], v[100:103], v[8:23]
    buffer_load_dwordx4 v[96:99], v1, s[24:27], s9 offen
    buffer_load_dwordx4 v[100:103], v1, s[24:27], s8 offen offset:1024
    s_add_u32 s9, s9, 16384
    s_waitcnt vmcnt(22)
    v_mfma_f32_32x32x16_bf16 v[8:23], v[104:107], v[108:111], v[8:23]
    buffer_load_dwordx4 v[104:107], v1, s[24:27], s9 offen
    buffer_load_dwordx4 v[108:111], v1, s[24:27], s8 offen offset:2048
    s_add_u32 s9, s9, 16384
    s_waitcnt vmcnt(22)
    v_mfma_f32_32x32x16_bf16 v[8:23], v[112:115], v[116:119], v[8:23]
    buffer_load_dwordx4 v[112:115], v1, s[24:27], s9 offen
    buffer_load_dwordx4 v[116:119], v1, s[24:27], s8 offen offset:3072
    s_add_u32 s9, s9, 16384
    s_waitcnt vmcnt(22)
    v_mfma_f32_32x32x16_bf16 v[8:23], v[24:27], v[28:31], v[8:23]
    s_add_u32 s8, s8, 4096
    buffer_load_dwordx4 v[24:27], v1, s[24:27], s9 offen
    buffer_load_dwordx4 v[28:31], v1, s[24:27], s8 offen offset:0
    s_add_u32 s9, s9, 16384
    s_waitcnt vmcnt(22)
    v_mfma_f32_32x32x16_bf16 v[8:23], v[32:35], v[36:39], v[8:23]
    buffer_load_dwordx4 v[32:35], v1, s[24:27], s9 offen
    buffer_load_dwordx4 v[36:39], v1, s[24:27], s8 offen offset:1024
    s_add_u32 s9, s9, 16384
    s_waitcnt vmcnt(22)
    v_mfma_f32_32x32x16_bf16 v[8:23], v[40:43], v[44:47], v[8:23]
    buffer_load_dwordx4 v[40:43], v1, s[24:27], s9 offen
    buffer_load_dwordx4 v[44:47], v1, s[24:27], s8 offen offset:2048
    s_add_u32 s9, s9, 16384
    s_waitcnt vmcnt(22)
    v_mfma_f32_32x32x16_bf16 v[8:23], v[48:51], v[52:55], v[8:23]
    buffer_load_dwordx4 v[48:51], v1, s[24:27], s9 offen
    buffer_load_dwordx4 v[52:55], v1, s[24:27], s8 offen offset:3072
    s_add_u32 s9, s9, 16384
    s_waitcnt vmcnt(22)
    v_mfma_f32_32x32x16_bf16 v[8:23], v[56:59], v[60:63], v[8:23]
    s_add_u32 s8, s8, 4096
    buffer_load_dwordx4 v[56:59], v1, s[24:27], s9 offen
    buffer_load_dwordx4 v[60:63], v1, s[24:27], s8 offen offset:0
    s_add_u32 s9, s9, 16384
    s_waitcnt vmcnt(22)
    v_mfma_f32_32x32x16_bf16 v[8:23], v[64:67], v[68:71], v[8:23]
    buffer_load_dwordx4 v[64:67], v1, s[24:27], s9 offen
    buffer_load_dwordx4 v[68:71], v1, s[24:27], s8 offen offset:1024
    s_add_u32 s9, s9, 16384
    s_waitcnt vmcnt(22)
    v_mfma_f32_32x32x16_bf16 v[8:23], v[72:75], v[76:79], v[8:23]
    buffer_load_dwordx4 v[72:75], v1, s[24:27], s9 offen
    buffer_load_dwordx4 v[76:79], v1, s[24:27], s8 offen offset:2048
    s_add_u32 s9, s9, 16384
    s_waitcnt vmcnt(22)
    v_mfma_f32_32x32x16_bf16 v[8:23], v[80:83], v[84:87], v[8:23]
    buffer_load_dwordx4 v[80:83], v1, s[24:27], s9 offen
    buffer_load_dwordx4 v[84:87], v1, s[24:27], s8 offen offset:3072
    s_add_u32 s9, s9, 16384
    s_waitcnt vmcnt(22)
    v_mfma_f32_32x32x16_bf16 v[8:23], v[88:91], v[92:95], v[8:23]
    s_add_u32 s8, s8, 4096
    buffer_load_dwordx4 v[88:91], v1, s[24:27], s9 offen
    buffer_load_dwordx4 v[92:95], v1, s[24:27], s8 offen offset:0
    s_add_u32 s9, s9, 16384
    s_waitcnt vmcnt(22)
    v_mfma_f32_32x32x16_bf16 v[8:23], v[96:99], v[100:103], v[8:23]
    buffer_load_dwordx4 v[96:99], v1, s[24:27], s9 offen
    buffer_load_dwordx4 v[100:103], v1, s[24:27], s8 offen offset:1024
    s_add_u32 s9, s9, 16384
    s_waitcnt vmcnt(22)
    v_mfma_f32_32x32x16_bf16 v[8:23], v[104:107], v[108:111], v[8:23]
    buffer_load_dwordx4 v[104:107], v1, s[24:27], s9 offen
    buffer_load_dwordx4 v[108:111], v1, s[24:27], s8 offen offset:2048
    s_add_u32 s9, s9, 16384
    s_waitcnt vmcnt(22)
    v_mfma_f32_32x32x16_bf16 v[8:23], v[112:115], v[116:119], v[8:23]
    buffer_load_dwordx4 v[112:115], v1, s[24:27], s9 offen
    buffer_load_dwordx4 v[116:119], v1, s[24:27], s8 offen offset:3072
    s_add_u32 s9, s9, 16384
    s_waitcnt vmcnt(22)
    v_mfma_f32_32x32x16_bf16 v[8:23], v[24:27], v[28:31], v[8:23]
    s_add_u32 s8, s8, 4096
    buffer_load_dwordx4 v[24:27], v1, s[24:27], s9 offen
    buffer_load_dwordx4 v[28:31], v1, s[24:27], s8 offen offset:0
    s_add_u32 s9, s9, 16384
    s_waitcnt vmcnt(22)
    v_mfma_f32_32x32x16_bf16 v[8:23], v[32:35], v[36:39], v[8:23]
    buffer_load_dwordx4 v[32:35], v1, s[24:27], s9 offen
    buffer_load_dwordx4 v[36:39], v1, s[24:27], s8 offen offset:1024
    s_add_u32 s9, s9, 16384
    s_waitcnt vmcnt(22)
    v_mfma_f32_32x32x16_bf16 v[8:23], v[40:43], v[44:47], v[8:23]
    buffer_load_dwordx4 v[40:43], v1, s[24:27], s9 offen
    buffer_load_dwordx4 v[44:47], v1, s[24:27], s8 offen offset:2048
    s_add_u32 s9, s9, 16384
    s_waitcnt vmcnt(22)
    v_mfma_f32_32x32x16_bf16 v[8:23], v[48:51], v[52:55], v[8:23]
    buffer_load_dwordx4 v[48:51], v1, s[24:27], s9 offen
    buffer_load_dwordx4 v[52:55], v1, s[24:27], s8 offen offset:3072
    s_add_u32 s9, s9, 16384
    s_waitcnt vmcnt(22)
    v_mfma_f32_32x32x16_bf16 v[8:23], v[56:59], v[60:63], v[8:23]
    s_add_u32 s8, s8, 4096
    buffer_load_dwordx4 v[56:59], v1, s[24:27], s9 offen
    buffer_load_dwordx4 v[60:63], v1, s[24:27], s8 offen offset:0
    s_add_u32 s9, s9, 16384
    s_waitcnt vmcnt(22)
    v_mfma_f32_32x32x16_bf16 v[8:23], v[64:67], v[68:71], v[8:23]
    buffer_load_dwordx4 v[64:67], v1, s[24:27], s9 offen
    buffer_load_dwordx4 v[68:71], v1, s[24:27], s8 offen offset:1024
    s_add_u32 s9, s9, 16384
    s_waitcnt vmcnt(22)
    v_mfma_f32_32x32x16_bf16 v[8:23], v[72:75], v[76:79], v[8:23]
    buffer_load_dwordx4 v[72:75], v1, s[24:27], s9 offen
    buffer_load_dwordx4 v[76:79], v1, s[24:27], s8 offen offset:2048
    s_add_u32 s9, s9, 16384
    s_waitcnt vmcnt(22)
    v_mfma_f32_32x32x16_bf16 v[8:23], v[80:83], v[84:87], v[8:23]
    buffer_load_dwordx4 v[80:83], v1, s[24:27], s9 offen
    buffer_load_dwordx4 v[84:87], v1, s[24:27], s8 offen offset:3072
    s_add_u32 s9, s9, 16384
    s_waitcnt vmcnt(22)
    v_mfma_f32_32x32x16_bf16 v[8:23], v[88:91], v[92:95], v[8:23]
    s_add_u32 s8, s8, 4096
    buffer_load_dwordx4 v[88:91], v1, s[24:27], s9 offen
    buffer_load_dwordx4 v[92:95], v1, s[24:27], s8 offen offset:0
    s_add_u32 s9, s9, 16384
    s_waitcnt vmcnt(22)
    v_mfma_f32_32x32x16_bf16 v[8:23], v[96:99], v[100:103], v[8:23]
    buffer_load_dwordx4 v[96:99], v1, s[24:27], s9 offen
    buffer_load_dwordx4 v[100:103], v1, s[24:27], s8 offen offset:1024
    s_add_u32 s9, s9, 16384
    s_waitcnt vmcnt(22)
    v_mfma_f32_32x32x16_bf16 v[8:23], v[104:107], v[108:111], v[8:23]
    buffer_load_dwordx4 v[104:107], v1, s[24:27], s9 offen
    buffer_load_dwordx4 v[108:111], v1, s[24:27], s8 offen offset:2048
    s_add_u32 s9, s9, 16384
    s_waitcnt vmcnt(22)
    v_mfma_f32_32x32x16_bf16 v[8:23], v[112:115], v[116:119], v[8:23]
    buffer_load_dwordx4 v[112:115], v1, s[24:27], s9 offen
    buffer_load_dwordx4 v[116:119], v1, s[24:27], s8 offen offset:3072
    s_add_u32 s9, s9, 16384
    s_waitcnt vmcnt(22)
    v_mfma_f32_32x32x16_bf16 v[8:23], v[24:27], v[28:31], v[8:23]
    s_add_u32 s8, s8, 4096
    buffer_load_dwordx4 v[24:27], v1, s[24:27], s9 offen
    buffer_load_dwordx4 v[28:31], v1, s[24:27], s8 offen offset:0
    s_add_u32 s9, s9, 16384
    s_waitcnt vmcnt(22)
    v_mfma_f32_32x32x16_bf16 v[8:23], v[32:35], v[36:39], v[8:23]
    buffer_load_dwordx4 v[32:35], v1, s[24:27], s9 offen
    buffer_load_dwordx4 v[36:39], v1, s[24:27], s8 offen offset:1024
    s_add_u32 s9, s9, 16384
    s_waitcnt vmcnt(22)
    v_mfma_f32_32x32x16_bf16 v[8:23], v[40:43], v[44:47], v[8:23]
    buffer_load_dwordx4 v[40:43], v1, s[24:27], s9 offen
    buffer_load_dwordx4 v[44:47], v1, s[24:27], s8 offen offset:2048
    s_add_u32 s9, s9, 16384
    s_waitcnt vmcnt(22)
    v_mfma_f32_32x32x16_bf16 v[8:23], v[48:51], v[52:55], v[8:23]
    buffer_load_dwordx4 v[48:51], v1, s[24:27], s9 offen
    buffer_load_dwordx4 v[52:55], v1, s[24:27], s8 offen offset:3072
    s_add_u32 s9, s9, 16384
    s_waitcnt vmcnt(22)
    v_mfma_f32_32x32x16_bf16 v[8:23], v[56:59], v[60:63], v[8:23]
    s_add_u32 s8, s8, 4096
    buffer_load_dwordx4 v[56:59], v1, s[24:27], s9 offen
    buffer_load_dwordx4 v[60:63], v1, s[24:27], s8 offen offset:0
    s_add_u32 s9, s9, 16384
    s_waitcnt vmcnt(22)
    v_mfma_f32_32x32x16_bf16 v[8:23], v[64:67], v[68:71], v[8:23]
    buffer_load_dwordx4 v[64:67], v1, s[24:27], s9 offen
    buffer_load_dwordx4 v[68:71], v1, s[24:27], s8 offen offset:1024
    s_add_u32 s9, s9, 16384
    s_waitcnt vmcnt(22)
    v_mfma_f32_32x32x16_bf16 v[8:23], v[72:75], v[76:79], v[8:23]
    buffer_load_dwordx4 v[72:75], v1, s[24:27], s9 offen
    buffer_load_dwordx4 v[76:79], v1, s[24:27], s8 offen offset:2048
    s_add_u32 s9, s9, 16384
    s_waitcnt vmcnt(22)
    v_mfma_f32_32x32x16_bf16 v[8:23], v[80:83], v[84:87], v[8:23]
    buffer_load_dwordx4 v[80:83], v1, s[24:27], s9 offen
    buffer_load_dwordx4 v[84:87], v1, s[24:27], s8 offen offset:3072
    s_add_u32 s9, s9, 16384
    s_waitcnt vmcnt(22)
    v_mfma_f32_32x32x16_bf16 v[8:23], v[88:91], v[92:95], v[8:23]
    s_add_u32 s8, s8, 4096
    buffer_load_dwordx4 v[88:91], v1, s[24:27], s9 offen
    buffer_load_dwordx4 v[92:95], v1, s[24:27], s8 offen offset:0
    s_add_u32 s9, s9, 16384
    s_waitcnt vmcnt(22)
    v_mfma_f32_32x32x16_bf16 v[8:23], v[96:99], v[100:103], v[8:23]
    buffer_load_dwordx4 v[96:99], v1, s[24:27], s9 offen
    buffer_load_dwordx4 v[100:103], v1, s[24:27], s8 offen offset:1024
    s_add_u32 s9, s9, 16384
    s_waitcnt vmcnt(22)
    v_mfma_f32_32x32x16_bf16 v[8:23], v[104:107], v[108:111], v[8:23]
    buffer_load_dwordx4 v[104:107], v1, s[24:27], s9 offen
    buffer_load_dwordx4 v[108:111], v1, s[24:27], s8 offen offset:2048
    s_add_u32 s9, s9, 16384
    s_waitcnt vmcnt(22)
    v_mfma_f32_32x32x16_bf16 v[8:23], v[112:115], v[116:119], v[8:23]
    buffer_load_dwordx4 v[112:115], v1, s[24:27], s9 offen
    buffer_load_dwordx4 v[116:119], v1, s[24:27], s8 offen offset:3072
    s_add_u32 s9, s9, 16384
    s_waitcnt vmcnt(22)
    v_mfma_f32_32x32x16_bf16 v[8:23], v[24:27], v[28:31], v[8:23]
    s_add_u32 s8, s8, 4096
    buffer_load_dwordx4 v[24:27], v1, s[24:27], s9 offen
    buffer_load_dwordx4 v[28:31], v1, s[24:27], s8 offen offset:0
    s_add_u32 s9, s9, 16384
    s_waitcnt vmcnt(22)
    v_mfma_f32_32x32x16_bf16 v[8:23], v[32:35], v[36:39], v[8:23]
    buffer_load_dwordx4 v[32:35], v1, s[24:27], s9 offen
    buffer_load_dwordx4 v[36:39], v1, s[24:27], s8 offen offset:1024
    s_add_u32 s9, s9, 16384
    s_waitcnt vmcnt(22)
    v_mfma_f32_32x32x16_bf16 v[8:23], v[40:43], v[44:47], v[8:23]
    buffer_load_dwordx4 v[40:43], v1, s[24:27], s9 offen
    buffer_load_dwordx4 v[44:47], v1, s[24:27], s8 offen offset:2048
    s_add_u32 s9, s9, 16384
    s_waitcnt vmcnt(22)
    v_mfma_f32_32x32x16_bf16 v[8:23], v[48:51], v[52:55], v[8:23]
    buffer_load_dwordx4 v[48:51], v1, s[24:27], s9 offen
    buffer_load_dwordx4 v[52:55], v1, s[24:27], s8 offen offset:3072
    s_add_u32 s9, s9, 16384
    s_waitcnt vmcnt(22)
    v_mfma_f32_32x32x16_bf16 v[8:23], v[56:59], v[60:63], v[8:23]
    s_add_u32 s8, s8, 4096
    buffer_load_dwordx4 v[56:59], v1, s[24:27], s9 offen
    buffer_load_dwordx4 v[60:63], v1, s[24:27], s8 offen offset:0
    s_add_u32 s9, s9, 16384
    s_waitcnt vmcnt(22)
    v_mfma_f32_32x32x16_bf16 v[8:23], v[64:67], v[68:71], v[8:23]
    buffer_load_dwordx4 v[64:67], v1, s[24:27], s9 offen
    buffer_load_dwordx4 v[68:71], v1, s[24:27], s8 offen offset:1024
    s_add_u32 s9, s9, 16384
    s_waitcnt vmcnt(22)
    v_mfma_f32_32x32x16_bf16 v[8:23], v[72:75], v[76:79], v[8:23]
    buffer_load_dwordx4 v[72:75], v1, s[24:27], s9 offen
    buffer_load_dwordx4 v[76:79], v1, s[24:27], s8 offen offset:2048
    s_add_u32 s9, s9, 16384
    s_waitcnt vmcnt(22)
    v_mfma_f32_32x32x16_bf16 v[8:23], v[80:83], v[84:87], v[8:23]
    buffer_load_dwordx4 v[80:83], v1, s[24:27], s9 offen
    buffer_load_dwordx4 v[84:87], v1, s[24:27], s8 offen offset:3072
    s_add_u32 s9, s9, 16384
    s_waitcnt vmcnt(22)
    v_mfma_f32_32x32x16_bf16 v[8:23], v[88:91], v[92:95], v[8:23]
    s_add_u32 s8, s8, 4096
    buffer_load_dwordx4 v[88:91], v1, s[24:27], s9 offen
    buffer_load_dwordx4 v[92:95], v1, s[24:27], s8 offen offset:0
    s_add_u32 s9, s9, 16384
    s_waitcnt vmcnt(22)
    v_mfma_f32_32x32x16_bf16 v[8:23], v[96:99], v[100:103], v[8:23]
    buffer_load_dwordx4 v[96:99], v1, s[24:27], s9 offen
    buffer_load_dwordx4 v[100:103], v1, s[24:27], s8 offen offset:1024
    s_add_u32 s9, s9, 16384
    s_waitcnt vmcnt(22)
    v_mfma_f32_32x32x16_bf16 v[8:23], v[104:107], v[108:111], v[8:23]
    buffer_load_dwordx4 v[104:107], v1, s[24:27], s9 offen
    buffer_load_dwordx4 v[108:111], v1, s[24:27], s8 offen offset:2048
    s_add_u32 s9, s9, 16384
    s_waitcnt vmcnt(22)
    v_mfma_f32_32x32x16_bf16 v[8:23], v[112:115], v[116:119], v[8:23]
    buffer_load_dwordx4 v[112:115], v1, s[24:27], s9 offen
    buffer_load_dwordx4 v[116:119], v1, s[24:27], s8 offen offset:3072
    s_add_u32 s9, s9, 16384
    s_waitcnt vmcnt(22)
    v_mfma_f32_32x32x16_bf16 v[8:23], v[24:27], v[28:31], v[8:23]
    s_add_u32 s8, s8, 4096
    buffer_load_dwordx4 v[24:27], v1, s[24:27], s9 offen
    buffer_load_dwordx4 v[28:31], v1, s[24:27], s8 offen offset:0
    s_add_u32 s9, s9, 16384
    s_waitcnt vmcnt(22)
    v_mfma_f32_32x32x16_bf16 v[8:23], v[32:35], v[36:39], v[8:23]
    buffer_load_dwordx4 v[32:35], v1, s[24:27], s9 offen
    buffer_load_dwordx4 v[36:39], v1, s[24:27], s8 offen offset:1024
    s_add_u32 s9, s9, 16384
    s_waitcnt vmcnt(22)
    v_mfma_f32_32x32x16_bf16 v[8:23], v[40:43], v[44:47], v[8:23]
    buffer_load_dwordx4 v[40:43], v1, s[24:27], s9 offen
    buffer_load_dwordx4 v[44:47], v1, s[24:27], s8 offen offset:2048
    s_add_u32 s9, s9, 16384
    s_waitcnt vmcnt(22)
    v_mfma_f32_32x32x16_bf16 v[8:23], v[48:51], v[52:55], v[8:23]
    buffer_load_dwordx4 v[48:51], v1, s[24:27], s9 offen
    buffer_load_dwordx4 v[52:55], v1, s[24:27], s8 offen offset:3072
    s_add_u32 s9, s9, 16384
    s_waitcnt vmcnt(22)
    v_mfma_f32_32x32x16_bf16 v[8:23], v[56:59], v[60:63], v[8:23]
    s_add_u32 s8, s8, 4096
    buffer_load_dwordx4 v[56:59], v1, s[24:27], s9 offen
    buffer_load_dwordx4 v[60:63], v1, s[24:27], s8 offen offset:0
    s_add_u32 s9, s9, 16384
    s_waitcnt vmcnt(22)
    v_mfma_f32_32x32x16_bf16 v[8:23], v[64:67], v[68:71], v[8:23]
    buffer_load_dwordx4 v[64:67], v1, s[24:27], s9 offen
    buffer_load_dwordx4 v[68:71], v1, s[24:27], s8 offen offset:1024
    s_add_u32 s9, s9, 16384
    s_waitcnt vmcnt(22)
    v_mfma_f32_32x32x16_bf16 v[8:23], v[72:75], v[76:79], v[8:23]
    buffer_load_dwordx4 v[72:75], v1, s[24:27], s9 offen
    buffer_load_dwordx4 v[76:79], v1, s[24:27], s8 offen offset:2048
    s_add_u32 s9, s9, 16384
    s_waitcnt vmcnt(22)
    v_mfma_f32_32x32x16_bf16 v[8:23], v[80:83], v[84:87], v[8:23]
    buffer_load_dwordx4 v[80:83], v1, s[24:27], s9 offen
    buffer_load_dwordx4 v[84:87], v1, s[24:27], s8 offen offset:3072
    s_add_u32 s9, s9, 16384
    s_waitcnt vmcnt(22)
    v_mfma_f32_32x32x16_bf16 v[8:23], v[88:91], v[92:95], v[8:23]
    s_add_u32 s8, s8, 4096
    buffer_load_dwordx4 v[88:91], v1, s[24:27], s9 offen
    buffer_load_dwordx4 v[92:95], v1, s[24:27], s8 offen offset:0
    s_add_u32 s9, s9, 16384
    s_waitcnt vmcnt(22)
    v_mfma_f32_32x32x16_bf16 v[8:23], v[96:99], v[100:103], v[8:23]
    buffer_load_dwordx4 v[96:99], v1, s[24:27], s9 offen
    buffer_load_dwordx4 v[100:103], v1, s[24:27], s8 offen offset:1024
    s_add_u32 s9, s9, 16384
    s_waitcnt vmcnt(22)
    v_mfma_f32_32x32x16_bf16 v[8:23], v[104:107], v[108:111], v[8:23]
    buffer_load_dwordx4 v[104:107], v1, s[24:27], s9 offen
    buffer_load_dwordx4 v[108:111], v1, s[24:27], s8 offen offset:2048
    s_add_u32 s9, s9, 16384
    s_waitcnt vmcnt(22)
    v_mfma_f32_32x32x16_bf16 v[8:23], v[112:115], v[116:119], v[8:23]
    buffer_load_dwordx4 v[112:115], v1, s[24:27], s9 offen
    buffer_load_dwordx4 v[116:119], v1, s[24:27], s8 offen offset:3072
    s_add_u32 s9, s9, 16384
    s_waitcnt vmcnt(22)
    v_mfma_f32_32x32x16_bf16 v[8:23], v[24:27], v[28:31], v[8:23]
    s_add_u32 s8, s8, 4096
    buffer_load_dwordx4 v[24:27], v1, s[24:27], s9 offen
    buffer_load_dwordx4 v[28:31], v1, s[24:27], s8 offen offset:0
    s_add_u32 s9, s9, 16384
    s_waitcnt vmcnt(22)
    v_mfma_f32_32x32x16_bf16 v[8:23], v[32:35], v[36:39], v[8:23]
    buffer_load_dwordx4 v[32:35], v1, s[24:27], s9 offen
    buffer_load_dwordx4 v[36:39], v1, s[24:27], s8 offen offset:1024
    s_add_u32 s9, s9, 16384
    s_waitcnt vmcnt(22)
    v_mfma_f32_32x32x16_bf16 v[8:23], v[40:43], v[44:47], v[8:23]
    s_waitcnt vmcnt(20)
    v_mfma_f32_32x32x16_bf16 v[8:23], v[48:51], v[52:55], v[8:23]
    s_waitcnt vmcnt(18)
    v_mfma_f32_32x32x16_bf16 v[8:23], v[56:59], v[60:63], v[8:23]
    s_waitcnt vmcnt(16)
    v_mfma_f32_32x32x16_bf16 v[8:23], v[64:67], v[68:71], v[8:23]
    s_waitcnt vmcnt(14)
    v_mfma_f32_32x32x16_bf16 v[8:23], v[72:75], v[76:79], v[8:23]
    s_waitcnt vmcnt(12)
    v_mfma_f32_32x32x16_bf16 v[8:23], v[80:83], v[84:87], v[8:23]
    s_waitcnt vmcnt(10)
    v_mfma_f32_32x32x16_bf16 v[8:23], v[88:91], v[92:95], v[8:23]
    s_waitcnt vmcnt(8)
    v_mfma_f32_32x32x16_bf16 v[8:23], v[96:99], v[100:103], v[8:23]
    s_waitcnt vmcnt(6)
    v_mfma_f32_32x32x16_bf16 v[8:23], v[104:107], v[108:111], v[8:23]
    s_waitcnt vmcnt(4)
    v_mfma_f32_32x32x16_bf16 v[8:23], v[112:115], v[116:119], v[8:23]
    s_waitcnt vmcnt(2)
    v_mfma_f32_32x32x16_bf16 v[8:23], v[24:27], v[28:31], v[8:23]
    s_waitcnt vmcnt(0)
    v_mfma_f32_32x32x16_bf16 v[8:23], v[32:35], v[36:39], v[8:23]
    buffer_load_dwordx4 v[24:27], v6, s[28:31], s13 offen
    buffer_load_dwordx4 v[28:31], v6, s[28:31], s13 offen offset:32
    s_mov_b32 s16, 0xbfb8aa3b
    s_lshl_b32 s12, s46, 14
    v_add_u32 v2, s12, v1
    s_nop 7
    s_nop 2
    v_mul_f32 v48, s16, v8
    v_mul_f32 v49, s16, v9
    v_mul_f32 v50, s16, v10
    v_mul_f32 v51, s16, v11
    v_mul_f32 v52, s16, v12
    v_mul_f32 v53, s16, v13
    v_mul_f32 v54, s16, v14
    v_mul_f32 v55, s16, v15
    v_mul_f32 v56, s16, v16
    v_mul_f32 v57, s16, v17
    v_mul_f32 v58, s16, v18
    v_mul_f32 v59, s16, v19
    v_mul_f32 v60, s16, v20
    v_mul_f32 v61, s16, v21
    v_mul_f32 v62, s16, v22
    v_mul_f32 v63, s16, v23
    v_exp_f32 v48, v48
    v_exp_f32 v49, v49
    v_exp_f32 v50, v50
    v_exp_f32 v51, v51
    v_exp_f32 v52, v52
    v_exp_f32 v53, v53
    v_exp_f32 v54, v54
    v_exp_f32 v55, v55
    v_exp_f32 v56, v56
    v_exp_f32 v57, v57
    v_exp_f32 v58, v58
    v_exp_f32 v59, v59
    v_exp_f32 v60, v60
    v_exp_f32 v61, v61
    v_exp_f32 v62, v62
    v_exp_f32 v63, v63
    v_add_f32 v48, 1.0, v48
    v_add_f32 v49, 1.0, v49
    v_add_f32 v50, 1.0, v50
    v_add_f32 v51, 1.0, v51
    v_add_f32 v52, 1.0, v52
    v_add_f32 v53, 1.0, v53
    v_add_f32 v54, 1.0, v54
    v_add_f32 v55, 1.0, v55
    v_add_f32 v56, 1.0, v56
    v_add_f32 v57, 1.0, v57
    v_add_f32 v58, 1.0, v58
    v_add_f32 v59, 1.0, v59
    v_add_f32 v60, 1.0, v60
    v_add_f32 v61, 1.0, v61
    v_add_f32 v62, 1.0, v62
    v_add_f32 v63, 1.0, v63
    v_rcp_f32 v48, v48
    v_rcp_f32 v49, v49
    v_rcp_f32 v50, v50
    v_rcp_f32 v51, v51
    v_rcp_f32 v52, v52
    v_rcp_f32 v53, v53
    v_rcp_f32 v54, v54
    v_rcp_f32 v55, v55
    v_rcp_f32 v56, v56
    v_rcp_f32 v57, v57
    v_rcp_f32 v58, v58
    v_rcp_f32 v59, v59
    v_rcp_f32 v60, v60
    v_rcp_f32 v61, v61
    v_rcp_f32 v62, v62
    v_rcp_f32 v63, v63
    v_mul_f32 v8, v8, v48
    v_mul_f32 v9, v9, v49
    v_mul_f32 v10, v10, v50
    v_mul_f32 v11, v11, v51
    v_mul_f32 v12, v12, v52
    v_mul_f32 v13, v13, v53
    v_mul_f32 v14, v14, v54
    v_mul_f32 v15, v15, v55
    v_mul_f32 v16, v16, v56
    v_mul_f32 v17, v17, v57
    v_mul_f32 v18, v18, v58
    v_mul_f32 v19, v19, v59
    v_mul_f32 v20, v20, v60
    v_mul_f32 v21, v21, v61
    v_mul_f32 v22, v22, v62
    v_mul_f32 v23, v23, v63
    s_waitcnt vmcnt(0)
    v_lshlrev_b32 v32, 16, v24
    v_and_b32 v33, 0xffff0000, v24
    v_lshlrev_b32 v34, 16, v25
    v_and_b32 v35, 0xffff0000, v25
    v_lshlrev_b32 v36, 16, v26
    v_and_b32 v37, 0xffff0000, v26
    v_lshlrev_b32 v38, 16, v27
    v_and_b32 v39, 0xffff0000, v27
    v_lshlrev_b32 v40, 16, v28
    v_and_b32 v41, 0xffff0000, v28
    v_lshlrev_b32 v42, 16, v29
    v_and_b32 v43, 0xffff0000, v29
    v_lshlrev_b32 v44, 16, v30
    v_and_b32 v45, 0xffff0000, v30
    v_lshlrev_b32 v46, 16, v31
    v_and_b32 v47, 0xffff0000, v31
    s_barrier
    s_barrier
    ds_read_b128 v[64:67], v2 offset:0
    ds_read_b128 v[68:71], v2 offset:1024
    ds_read_b128 v[72:75], v2 offset:2048
    ds_read_b128 v[76:79], v2 offset:3072
    ds_read_b128 v[80:83], v2 offset:4096
    ds_read_b128 v[84:87], v2 offset:5120
    ds_read_b128 v[88:91], v2 offset:6144
    ds_read_b128 v[92:95], v2 offset:7168
    ds_read_b128 v[96:99], v2 offset:8192
    ds_read_b128 v[100:103], v2 offset:9216
    ds_read_b128 v[104:107], v2 offset:10240
    ds_read_b128 v[108:111], v2 offset:11264
    ds_read_b128 v[112:115], v2 offset:12288
    ds_read_b128 v[116:119], v2 offset:13312
    ds_read_b128 v[120:123], v2 offset:14336
    ds_read_b128 v[124:127], v2 offset:15360
    s_waitcnt lgkmcnt(8)
    v_pk_add_f32 v[64:65], v[64:65], v[80:81]
    v_pk_add_f32 v[66:67], v[66:67], v[82:83]
    v_pk_add_f32 v[68:69], v[68:69], v[84:85]
    v_pk_add_f32 v[70:71], v[70:71], v[86:87]
    v_pk_add_f32 v[72:73], v[72:73], v[88:89]
    v_pk_add_f32 v[74:75], v[74:75], v[90:91]
    v_pk_add_f32 v[76:77], v[76:77], v[92:93]
    v_pk_add_f32 v[78:79], v[78:79], v[94:95]
    s_waitcnt lgkmcnt(4)
    v_pk_add_f32 v[64:65], v[64:65], v[96:97]
    v_pk_add_f32 v[66:67], v[66:67], v[98:99]
    v_pk_add_f32 v[68:69], v[68:69], v[100:101]
    v_pk_add_f32 v[70:71], v[70:71], v[102:103]
    v_pk_add_f32 v[72:73], v[72:73], v[104:105]
    v_pk_add_f32 v[74:75], v[74:75], v[106:107]
    v_pk_add_f32 v[76:77], v[76:77], v[108:109]
    v_pk_add_f32 v[78:79], v[78:79], v[110:111]
    s_waitcnt lgkmcnt(0)
    v_pk_add_f32 v[64:65], v[64:65], v[112:113]
    v_pk_add_f32 v[66:67], v[66:67], v[114:115]
    v_pk_add_f32 v[68:69], v[68:69], v[116:117]
    v_pk_add_f32 v[70:71], v[70:71], v[118:119]
    v_pk_add_f32 v[72:73], v[72:73], v[120:121]
    v_pk_add_f32 v[74:75], v[74:75], v[122:123]
    v_pk_add_f32 v[76:77], v[76:77], v[124:125]
    v_pk_add_f32 v[78:79], v[78:79], v[126:127]
    v_pk_mul_f32 v[64:65], v[64:65], v[8:9]
    v_pk_mul_f32 v[66:67], v[66:67], v[10:11]
    v_pk_mul_f32 v[68:69], v[68:69], v[12:13]
    v_pk_mul_f32 v[70:71], v[70:71], v[14:15]
    v_pk_mul_f32 v[72:73], v[72:73], v[16:17]
    v_pk_mul_f32 v[74:75], v[74:75], v[18:19]
    v_pk_mul_f32 v[76:77], v[76:77], v[20:21]
    v_pk_mul_f32 v[78:79], v[78:79], v[22:23]
    s_nop 0
    v_permlane32_swap_b32 v64, v68
    v_permlane32_swap_b32 v65, v69
    v_permlane32_swap_b32 v66, v70
    v_permlane32_swap_b32 v67, v71
    v_permlane32_swap_b32 v72, v76
    v_permlane32_swap_b32 v73, v77
    v_permlane32_swap_b32 v74, v78
    v_permlane32_swap_b32 v75, v79
    s_nop 0
    v_pk_add_f32 v[64:65], v[64:65], v[32:33]
    v_pk_add_f32 v[66:67], v[66:67], v[34:35]
    v_pk_add_f32 v[68:69], v[68:69], v[36:37]
    v_pk_add_f32 v[70:71], v[70:71], v[38:39]
    v_pk_add_f32 v[72:73], v[72:73], v[40:41]
    v_pk_add_f32 v[74:75], v[74:75], v[42:43]
    v_pk_add_f32 v[76:77], v[76:77], v[44:45]
    v_pk_add_f32 v[78:79], v[78:79], v[46:47]
    v_cvt_pk_bf16_f32 v48, v64, v65
    v_cvt_pk_bf16_f32 v49, v66, v67
    v_cvt_pk_bf16_f32 v50, v68, v69
    v_cvt_pk_bf16_f32 v51, v70, v71
    v_cvt_pk_bf16_f32 v52, v72, v73
    v_cvt_pk_bf16_f32 v53, v74, v75
    v_cvt_pk_bf16_f32 v54, v76, v77
    v_cvt_pk_bf16_f32 v55, v78, v79
    buffer_store_dwordx4 v[48:51], v6, s[32:35], s13 offen
    buffer_store_dwordx4 v[52:55], v6, s[32:35], s13 offen offset:32
    s_endpgm
attn_kernel_end:
    s_endpgm
.section .rodata,"a"
.p2align 6
.amdhsa_kernel proj_kernel
  .amdhsa_next_free_vgpr 256
  .amdhsa_next_free_sgpr 96
  .amdhsa_accum_offset 256
  .amdhsa_group_segment_fixed_size 0
  .amdhsa_kernarg_size 80
  .amdhsa_user_sgpr_count 2
  .amdhsa_user_sgpr_kernarg_segment_ptr 1
  .amdhsa_system_sgpr_workgroup_id_x 1
.end_amdhsa_kernel
.p2align 6
.amdhsa_kernel attn_kernel
  .amdhsa_next_free_vgpr 168
  .amdhsa_next_free_sgpr 96
  .amdhsa_accum_offset 168
  .amdhsa_group_segment_fixed_size 0
  .amdhsa_kernarg_size 80
  .amdhsa_user_sgpr_count 2
  .amdhsa_user_sgpr_kernarg_segment_ptr 1
  .amdhsa_system_sgpr_workgroup_id_x 1
.end_amdhsa_kernel
```
